```python
import torch

def _softmax(x, axis=-1):
    return torch.softmax(x, dim=axis)
def _gelu(x):
    return torch.nn.functional.gelu(x, approximate="tanh")
def _silu(x):
    return torch.nn.functional.silu(x)
def _sigmoid(x):
    return torch.sigmoid(x)
def _layernorm(x, axis=-1, eps=1e-5):
    m = x.mean(dim=axis, keepdim=True)
    v = x.var(dim=axis, keepdim=True, unbiased=False)
    return (x - m) / torch.sqrt(v + eps)
def _scatter_add(tgt, idx, src, axis=0):
    return tgt.clone().index_add_(axis, idx, src)
def _segment_sum(src, seg, n):
    out = torch.zeros((n,) + src.shape[1:], dtype=src.dtype)
    return out.index_add_(0, seg, src)
def _pad(x, pw):
    flat = tuple(v for pair in reversed(pw) for v in pair)
    return torch.nn.functional.pad(x, flat)

kernel_name = 'standalone__paged_block_table_kv_pagedattention__sampling'

def setup_inputs():

    _w = (lambda a: (lambda t: t.to(torch.bfloat16) if t.is_floating_point() else t)(torch.as_tensor(a)))
    B, Hq, Hkv, Sq, Skv, D = 16, 32, 16, 16, 4096, 128
    bs = 16
    nbps = max(1, Skv // bs)
    num_phys = B * nbps + 4
    bt = torch.randperm(num_phys)[: B * nbps].reshape(B, nbps).to(torch.int64)
    cl = (nbps * bs - (torch.arange(1, B + 1, dtype=torch.int64) * 2654435761) % max(1, nbps * bs // 2)).to(torch.int64)
    return {
        "q": _w((lambda *s: torch.randn(*s, dtype=torch.bfloat16) * 0.8)(B, Hq, Sq, D)),
        "k_cache": _w((lambda *s: torch.randn(*s, dtype=torch.bfloat16) * 0.8)(num_phys, bs, Hkv, D)),
        "v_cache": _w((lambda *s: torch.randn(*s, dtype=torch.bfloat16) * 0.05)(num_phys, bs, Hkv, D)),
        "block_table": _w(bt),
        "context_lens": _w(cl),
    }

def reference(q, k_cache, v_cache, block_table, context_lens):
    B, Hq, Sq, D = q.shape
    bs = k_cache.shape[1]
    Hkv = k_cache.shape[2]
    nbps = block_table.shape[1]
    Skv = nbps * bs
    bt = block_table.reshape(-1)
    k = (lambda x, *d: x.permute(*d))(k_cache[bt].reshape(B, Skv, Hkv, D), 0, 2, 1, 3)
    v = (lambda x, *d: x.permute(*d))(v_cache[bt].reshape(B, Skv, Hkv, D), 0, 2, 1, 3)
    g = Hq // Hkv
    qg = q.reshape(B, Hkv, g, Sq, D)
    scores = torch.einsum("bhgqd,bhkd->bhgqk", qg, k) * (D ** -0.5)
    pos = torch.arange(Skv)
    msk = pos[None, :] < context_lens[:, None]
    scores = torch.where(msk[:, None, None, None, :], scores, -1e9)
    p = _softmax(scores, axis=-1)
    out = torch.einsum("bhgqk,bhkd->bhgqd", p, v)
    return out.reshape(B, Hq, Sq, D)
```

```asm
; @launch grid=(256,1,1) block=(256,1,1) lds=133120
.amdgcn_target "amdgcn-amd-amdhsa--gfx950"
.text
.globl standalone__paged_block_table_kv_pagedattention__sampling_kernel
.p2align 8
.type standalone__paged_block_table_kv_pagedattention__sampling_kernel,@function
standalone__paged_block_table_kv_pagedattention__sampling_kernel:
    s_cmp_ge_u32 s2, 256
    s_cbranch_scc1 L_done
    s_load_dwordx16 s[4:19], s[0:1], 0
    s_lshr_b32 s52, s2, 4
    s_and_b32 s53, s2, 15
    v_lshrrev_b32 v1, 6, v0
    v_lshlrev_b32 v4, 4, v0
    v_and_b32 v0, 63, v0
    v_readfirstlane_b32 s54, v1
    v_lshlrev_b32 v1, 2, v0
    v_lshrrev_b32 v2, 4, v0
    v_and_b32 v3, 15, v0
    v_lshlrev_b32 v11, 2, v2
    s_mov_b32 s55, 0x3e0293ee
    s_lshl_b32 s56, s54, 15
    s_lshl_b32 s63, s53, 8
    s_mov_b32 s98, s54
    s_lshl_b32 s64, s52, 10
    s_lshl_b32 s65, s98, 2
    s_add_u32 s64, s64, s65
    s_add_u32 s65, s64, 16
    s_lshl_b32 s66, s52, 2
    s_mov_b32 s38, 16384
    s_mov_b32 s39, 0x20000
    s_mov_b32 s50, 64
    s_mov_b32 s51, 0x20000
    s_waitcnt lgkmcnt(0)
    s_load_dword s60, s[10:11], s64
    s_load_dword s61, s[10:11], s65
    s_load_dword s66, s[12:13], s66
    s_mov_b32 s48, s12
    s_and_b32 s49, s13, 0xffff
    s_mov_b32 s36, s10
    s_and_b32 s37, s11, 0xffff
    buffer_load_dword v236, v1, s[48:51], 0 offen
    s_mov_b32 s84, 4096
    s_mov_b32 s85, 8192
    s_mov_b32 s86, 12288
    buffer_load_dwordx4 v[172:175], v4, s[36:39], 0 offen
    buffer_load_dwordx4 v[176:179], v4, s[36:39], s84 offen
    buffer_load_dwordx4 v[180:183], v4, s[36:39], s85 offen
    buffer_load_dwordx4 v[184:187], v4, s[36:39], s86 offen
    s_mov_b32 s20, s6
    s_and_b32 s21, s7, 0xffff
    s_mov_b32 s22, 268697600
    s_mov_b32 s23, 0x20000
    s_mov_b32 s24, s8
    s_and_b32 s25, s9, 0xffff
    s_mov_b32 s26, 268697600
    s_mov_b32 s27, 0x20000
    v_add_u32 v4, 0, v2
    v_and_b32 v5, 7, v4
    v_lshlrev_b32 v5, 1, v5
    v_xor_b32 v5, v5, v3
    v_lshlrev_b32 v4, 12, v4
    v_lshl_add_u32 v4, v5, 4, v4
    v_add_u32 v12, s63, v4
    v_add_u32 v4, 4, v2
    v_and_b32 v5, 7, v4
    v_lshlrev_b32 v5, 1, v5
    v_xor_b32 v5, v5, v3
    v_lshlrev_b32 v4, 12, v4
    v_lshl_add_u32 v4, v5, 4, v4
    v_add_u32 v4, s63, v4
    v_subrev_u32 v13, 1024, v4
    v_add_u32 v4, 8, v2
    v_and_b32 v5, 7, v4
    v_lshlrev_b32 v5, 1, v5
    v_xor_b32 v5, v5, v3
    v_lshlrev_b32 v4, 12, v4
    v_lshl_add_u32 v4, v5, 4, v4
    v_add_u32 v4, s63, v4
    v_subrev_u32 v14, 2048, v4
    v_add_u32 v4, 12, v2
    v_and_b32 v5, 7, v4
    v_lshlrev_b32 v5, 1, v5
    v_xor_b32 v5, v5, v3
    v_lshlrev_b32 v4, 12, v4
    v_lshl_add_u32 v4, v5, 4, v4
    v_add_u32 v4, s63, v4
    v_subrev_u32 v15, 3072, v4
    s_mov_b32 s57, s56
    s_lshl_b32 s64, s98, 4
    s_waitcnt lgkmcnt(0)
    s_lshl_b32 s60, s60, 16
    s_lshl_b32 s61, s61, 16
    s_cmp_lt_i32 s66, 1
    s_cselect_b32 s65, 4096, s66
    s_cmp_lt_i32 s64, s65
    s_cselect_b32 s60, s60, 268697600
    s_add_u32 s64, s64, 64
    s_cmp_lt_i32 s64, s65
    s_cselect_b32 s61, s61, 268697600
    s_mov_b32 m0, s57
    s_nop 0
    buffer_load_dwordx4 v12, s[20:23], s60 offen nt lds
    buffer_load_dwordx4 v13, s[20:23], s60 offen offset:1024 nt lds
    buffer_load_dwordx4 v14, s[20:23], s60 offen offset:2048 nt lds
    buffer_load_dwordx4 v15, s[20:23], s60 offen offset:3072 nt lds
    s_add_u32 m0, s57, 4096
    s_nop 0
    buffer_load_dwordx4 v12, s[20:23], s61 offen nt lds
    buffer_load_dwordx4 v13, s[20:23], s61 offen offset:1024 nt lds
    buffer_load_dwordx4 v14, s[20:23], s61 offen offset:2048 nt lds
    buffer_load_dwordx4 v15, s[20:23], s61 offen offset:3072 nt lds
    v_and_b32 v5, 7, v3
    v_lshlrev_b32 v5, 1, v5
    v_lshlrev_b32 v6, 8, v3
    v_lshl_add_u32 v40, v2, 4, v6
    v_add_u32 v6, s56, v6
    v_add_u32 v4, 0, v2
    v_xor_b32 v4, v4, v5
    v_lshl_add_u32 v16, v4, 4, v6
    v_add_u32 v4, 4, v2
    v_xor_b32 v4, v4, v5
    v_lshl_add_u32 v17, v4, 4, v6
    v_add_u32 v4, 8, v2
    v_xor_b32 v4, v4, v5
    v_lshl_add_u32 v18, v4, 4, v6
    v_add_u32 v4, 12, v2
    v_xor_b32 v4, v4, v5
    v_lshl_add_u32 v19, v4, 4, v6
    s_mov_b32 s28, s4
    s_and_b32 s29, s5, 0xffff
    s_mov_b32 s30, 2097152
    s_mov_b32 s31, 0x20000
    v_mov_b32 v5, 4096
    v_sub_u32 v6, 15, v3
    s_waitcnt vmcnt(12)
    v_min_i32 v237, v5, v236
    v_cmp_gt_i32 vcc, 1, v236
    s_nop 1
    v_cndmask_b32 v237, v237, v5, vcc
    v_add_u32 v238, 15, v237
    v_lshrrev_b32 v238, 4, v238
    v_lshl_or_b32 v239, v238, 4, v6
    v_readlane_b32 s69, v238, s52
    v_readlane_b32 s71, v237, s52
    v_subrev_u32_dpp v108, v239, v239 row_ror:1 row_mask:0xf bank_mask:0xf
    v_subrev_u32_dpp v109, v239, v239 row_ror:2 row_mask:0xf bank_mask:0xf
    v_subrev_u32_dpp v110, v239, v239 row_ror:3 row_mask:0xf bank_mask:0xf
    v_subrev_u32_dpp v111, v239, v239 row_ror:4 row_mask:0xf bank_mask:0xf
    v_subrev_u32_dpp v112, v239, v239 row_ror:5 row_mask:0xf bank_mask:0xf
    v_subrev_u32_dpp v113, v239, v239 row_ror:6 row_mask:0xf bank_mask:0xf
    v_subrev_u32_dpp v114, v239, v239 row_ror:7 row_mask:0xf bank_mask:0xf
    v_subrev_u32_dpp v115, v239, v239 row_ror:8 row_mask:0xf bank_mask:0xf
    v_subrev_u32_dpp v116, v239, v239 row_ror:9 row_mask:0xf bank_mask:0xf
    v_subrev_u32_dpp v117, v239, v239 row_ror:10 row_mask:0xf bank_mask:0xf
    v_subrev_u32_dpp v118, v239, v239 row_ror:11 row_mask:0xf bank_mask:0xf
    v_subrev_u32_dpp v119, v239, v239 row_ror:12 row_mask:0xf bank_mask:0xf
    v_subrev_u32_dpp v120, v239, v239 row_ror:13 row_mask:0xf bank_mask:0xf
    v_subrev_u32_dpp v121, v239, v239 row_ror:14 row_mask:0xf bank_mask:0xf
    v_subrev_u32_dpp v122, v239, v239 row_ror:15 row_mask:0xf bank_mask:0xf
    v_lshrrev_b32 v108, 31, v108
    v_lshrrev_b32 v109, 31, v109
    v_lshrrev_b32 v110, 31, v110
    v_lshrrev_b32 v111, 31, v111
    v_lshrrev_b32 v112, 31, v112
    v_lshrrev_b32 v113, 31, v113
    v_lshrrev_b32 v114, 31, v114
    v_lshrrev_b32 v115, 31, v115
    v_lshrrev_b32 v116, 31, v116
    v_lshrrev_b32 v117, 31, v117
    v_lshrrev_b32 v118, 31, v118
    v_lshrrev_b32 v119, 31, v119
    v_lshrrev_b32 v120, 31, v120
    v_lshrrev_b32 v121, 31, v121
    v_lshrrev_b32 v122, 31, v122
    v_add3_u32 v108, v108, v109, v110
    v_add3_u32 v111, v111, v112, v113
    v_add3_u32 v114, v114, v115, v116
    v_add3_u32 v117, v117, v118, v119
    v_add3_u32 v120, v120, v121, v122
    v_add3_u32 v108, v108, v111, v114
    v_add3_u32 v240, v108, v117, v120
    v_add_u32_dpp v109, v238, v238 row_ror:1 row_mask:0xf bank_mask:0xf
    s_nop 1
    v_add_u32_dpp v109, v109, v109 row_ror:2 row_mask:0xf bank_mask:0xf
    s_nop 1
    v_add_u32_dpp v109, v109, v109 row_ror:4 row_mask:0xf bank_mask:0xf
    s_nop 1
    v_add_u32_dpp v109, v109, v109 row_ror:8 row_mask:0xf bank_mask:0xf
    s_nop 0
    v_readlane_b32 s82, v109, 0
    s_nop 0
    v_readlane_b32 s67, v240, s52
    s_nop 3
    s_sub_u32 s63, 15, s67
    v_cmp_eq_u32 vcc, s63, v240
    s_nop 3
    s_ff1_i32_b32 s68, vcc_lo
    v_readlane_b32 s70, v238, s68
    v_readlane_b32 s72, v237, s68
    v_readlane_b32 s65, v236, s68
    v_readlane_b32 s67, v239, s52
    v_readlane_b32 s64, v239, s68
    s_nop 3
    s_max_u32 s84, s69, s70
    s_min_u32 s85, s69, s70
    s_add_u32 s85, s85, 7
    s_andn2_b32 s85, s85, 7
    s_add_u32 s63, s84, s85
    s_add_u32 s63, s63, 18
    s_lshr_b32 s63, s63, 1
    s_andn2_b32 s63, s63, 7
    s_sub_i32 s73, s84, s63
    s_cmp_lt_i32 s73, 4
    s_cselect_b32 s73, 0, s73
    s_cmp_gt_u32 s67, s64
    s_cselect_b32 s77, s73, 0
    s_cselect_b32 s76, 0, s73
    s_cselect_b32 s63, s52, s68
    s_mov_b32 s67, s76
    s_sub_u32 s69, s69, s77
    s_lshl_b32 s84, s69, 4
    s_min_u32 s71, s71, s84
    s_sub_u32 s70, s70, s76
    s_cmp_lg_u32 s76, 0
    s_cselect_b32 s84, s70, 8
    s_cselect_b32 s85, s68, s52
    s_cselect_b32 s87, s72, s71
    s_add_u32 s84, s84, s98
    s_lshl_b32 s85, s85, 8
    s_add_u32 s85, s85, s84
    s_lshl_b32 s85, s85, 2
    s_add_u32 s86, s85, 16
    s_buffer_load_dword s85, s[36:39], s85
    s_buffer_load_dword s86, s[36:39], s86
    s_lshl_b32 s63, s63, 4
    s_add_u32 s63, s63, s53
    s_mul_i32 s79, s63, 20480
    s_add_u32 s79, s79, 1048576
    s_andn2_b32 s80, s63, 3
    s_and_b32 s81, s63, 3
    s_lshl_b32 s81, s81, 3
    s_add_u32 s75, s69, 7
    s_lshr_b32 s75, s75, 3
    s_add_u32 s74, s76, 7
    s_lshr_b32 s74, s74, 3
    s_lshl_b32 s63, s53, 13
    s_lshl_b32 s78, s52, 17
    s_add_u32 s78, s78, s63
    s_cmp_lt_i32 s66, 1
    s_cselect_b32 s78, 0x7fff0000, s78
    s_lshl_b32 s66, s68, 17
    s_add_u32 s66, s66, s63
    s_cmp_lt_i32 s65, 1
    s_cselect_b32 s66, 0x7fff0000, s66
    s_add_u32 s63, s78, 4096
    buffer_load_dwordx4 v[44:47], v40, s[28:31], s78 offen offset:0
    buffer_load_dwordx4 v[48:51], v40, s[28:31], s78 offen offset:64
    buffer_load_dwordx4 v[52:55], v40, s[28:31], s78 offen offset:128
    buffer_load_dwordx4 v[56:59], v40, s[28:31], s78 offen offset:192
    buffer_load_dwordx4 v[60:63], v40, s[28:31], s63 offen offset:0
    buffer_load_dwordx4 v[64:67], v40, s[28:31], s63 offen offset:64
    buffer_load_dwordx4 v[68:71], v40, s[28:31], s63 offen offset:128
    buffer_load_dwordx4 v[72:75], v40, s[28:31], s63 offen offset:192
    s_cmp_eq_u32 s76, 0
    s_cselect_b32 s59, s75, 1
    s_cbranch_scc1 L_noq2
    s_add_u32 s63, s66, 4096
    buffer_load_dwordx4 v[76:79], v40, s[28:31], s66 offen offset:0
    buffer_load_dwordx4 v[80:83], v40, s[28:31], s66 offen offset:64
    buffer_load_dwordx4 v[84:87], v40, s[28:31], s66 offen offset:128
    buffer_load_dwordx4 v[88:91], v40, s[28:31], s66 offen offset:192
    buffer_load_dwordx4 v[92:95], v40, s[28:31], s63 offen offset:0
    buffer_load_dwordx4 v[96:99], v40, s[28:31], s63 offen offset:64
    buffer_load_dwordx4 v[100:103], v40, s[28:31], s63 offen offset:128
    buffer_load_dwordx4 v[104:107], v40, s[28:31], s63 offen offset:192
    s_mov_b32 s76, 2
L_noq2:
    s_add_u32 s63, s70, s98
    s_sub_u32 s63, s63, 8
    v_subrev_u32 v4, 1, v0
    v_cmp_gt_u32 vcc, s74, v4
    v_subrev_u32 v4, s74, v0
    v_max_i32 v4, 0, v4
    v_lshl_add_u32 v4, v4, 3, s98
    v_lshl_add_u32 v5, v0, 3, s63
    v_mov_b32 v6, s71
    v_mov_b32 v7, s72
    v_cndmask_b32 v1, v4, v5, vcc
    v_cndmask_b32 v6, v6, v7, vcc
    v_mov_b32 v5, s52
    v_mov_b32 v7, s68
    v_lshlrev_b32 v4, 2, v1
    v_cndmask_b32 v5, v5, v7, vcc
    v_lshl_add_u32 v4, v5, 10, v4
    buffer_load_dword v8, v4, s[36:39], 0 offen
    buffer_load_dword v9, v4, s[36:39], 0 offen offset:16
    s_add_u32 m0, s57, 8192
    s_nop 0
    buffer_load_dwordx4 v12, s[24:27], s60 offen nt lds
    buffer_load_dwordx4 v13, s[24:27], s60 offen offset:1024 nt lds
    buffer_load_dwordx4 v14, s[24:27], s60 offen offset:2048 nt lds
    buffer_load_dwordx4 v15, s[24:27], s60 offen offset:3072 nt lds
    s_add_u32 m0, s57, 12288
    s_nop 0
    buffer_load_dwordx4 v12, s[24:27], s61 offen nt lds
    buffer_load_dwordx4 v13, s[24:27], s61 offen offset:1024 nt lds
    buffer_load_dwordx4 v14, s[24:27], s61 offen offset:2048 nt lds
    buffer_load_dwordx4 v15, s[24:27], s61 offen offset:3072 nt lds
    s_lshl_b32 s84, s84, 4
    s_waitcnt lgkmcnt(0)
    s_lshl_b32 s85, s85, 16
    s_lshl_b32 s86, s86, 16
    s_cmp_lt_u32 s84, s87
    s_cselect_b32 s85, s85, 268697600
    s_add_u32 s84, s84, 64
    s_cmp_lt_u32 s84, s87
    s_cselect_b32 s86, s86, 268697600
    s_add_u32 m0, s57, 16384
    s_nop 0
    buffer_load_dwordx4 v12, s[20:23], s85 offen nt lds
    buffer_load_dwordx4 v13, s[20:23], s85 offen offset:1024 nt lds
    buffer_load_dwordx4 v14, s[20:23], s85 offen offset:2048 nt lds
    buffer_load_dwordx4 v15, s[20:23], s85 offen offset:3072 nt lds
    s_add_u32 m0, s57, 20480
    s_nop 0
    buffer_load_dwordx4 v12, s[20:23], s86 offen nt lds
    buffer_load_dwordx4 v13, s[20:23], s86 offen offset:1024 nt lds
    buffer_load_dwordx4 v14, s[20:23], s86 offen offset:2048 nt lds
    buffer_load_dwordx4 v15, s[20:23], s86 offen offset:3072 nt lds
    v_lshlrev_b32 v4, 4, v1
    v_sub_u32 v4, v6, v4
    v_subrev_u32 v5, 64, v4
    v_med3_i32 v4, v4, 0, 16
    v_med3_i32 v5, v5, 0, 16
    v_lshl_or_b32 v10, v5, 8, v4
    v_cmp_lt_i32 vcc, 0, v4
    v_cmp_lt_i32 s[64:65], 0, v5
    v_bfe_u32 v4, v0, 2, 2
    v_add_u32 v4, v11, v4
    v_and_b32 v5, 7, v4
    v_lshlrev_b32 v5, 1, v5
    v_lshlrev_b32 v6, 8, v4
    v_add_u32 v6, s56, v6
    v_and_b32 v7, 1, v0
    v_lshl_add_u32 v6, v7, 3, v6
    v_bfe_u32 v7, v0, 1, 1
    v_add_u32 v4, 0, v7
    v_xor_b32 v4, v4, v5
    v_lshl_add_u32 v20, v4, 4, v6
    v_add_u32 v4, 2, v7
    v_xor_b32 v4, v4, v5
    v_lshl_add_u32 v21, v4, 4, v6
    v_add_u32 v4, 4, v7
    v_xor_b32 v4, v4, v5
    v_lshl_add_u32 v22, v4, 4, v6
    v_add_u32 v4, 6, v7
    v_xor_b32 v4, v4, v5
    v_lshl_add_u32 v23, v4, 4, v6
    v_add_u32 v4, 8, v7
    v_xor_b32 v4, v4, v5
    v_lshl_add_u32 v24, v4, 4, v6
    v_add_u32 v4, 10, v7
    v_xor_b32 v4, v4, v5
    v_lshl_add_u32 v25, v4, 4, v6
    v_add_u32 v4, 12, v7
    v_xor_b32 v4, v4, v5
    v_lshl_add_u32 v26, v4, 4, v6
    v_add_u32 v4, 14, v7
    v_xor_b32 v4, v4, v5
    v_lshl_add_u32 v27, v4, 4, v6
    s_mov_b32 s32, s14
    s_and_b32 s33, s15, 0xffff
    s_mov_b32 s34, 2097152
    s_mov_b32 s35, 0x20000
    s_mov_b32 s40, s18
    s_and_b32 s41, s19, 0xffff
    s_mov_b32 s42, 1074790400
    s_mov_b32 s43, 0x20000
    s_mov_b32 s44, s16
    s_and_b32 s45, s17, 0xffff
    s_mov_b32 s46, 256
    s_mov_b32 s47, 0x20000
    s_mov_b32 s58, 2
    s_sub_u32 s73, s69, 1
    s_and_b32 s73, s73, 7
    s_cmp_lt_u32 s73, 4
    s_cselect_b32 s73, 3, 2
    s_lshr_b32 s83, s6, 8
    s_add_u32 s83, s83, s53
    s_and_b32 s83, s83, 3
    s_lshl_b32 s63, s75, 3
    s_cmp_lg_u32 s67, 0
    s_cselect_b32 s84, 13, 0
    s_add_u32 s63, s63, s84
    s_add_u32 s63, s63, s67
    s_lshr_b32 s82, s82, 4
    s_sub_i32 s63, s63, s82
    s_cmp_ge_i32 s63, 12
    s_cselect_b32 s84, 2, 0
    s_cmp_le_i32 s63, 1
    s_cselect_b32 s84, 3, s84
    s_cmp_eq_u32 s83, 1
    s_cselect_b32 s83, 1, s84
    v_readlane_b32 s62, v10, 0
    v_mov_b32 v6, 4100
    s_waitcnt vmcnt(16)
    v_cndmask_b32 v8, v6, v8, vcc
    v_cndmask_b32 v9, v6, v9, s[64:65]
    v_lshlrev_b32 v8, 16, v8
    v_lshlrev_b32 v9, 16, v9
    ds_read_b128 v[172:175], v16
    ds_read_b128 v[176:179], v17
    ds_read_b128 v[180:183], v18
    ds_read_b128 v[184:187], v19
    ds_read_b128 v[188:191], v16 offset:4096
    ds_read_b128 v[192:195], v17 offset:4096
    ds_read_b128 v[196:199], v18 offset:4096
    ds_read_b128 v[200:203], v19 offset:4096
    s_waitcnt lgkmcnt(7)
    v_mfma_f32_16x16x32_bf16 v[220:223], v[172:175], v[44:47], 0
    v_mfma_f32_16x16x32_bf16 v[224:227], v[172:175], v[60:63], 0
    s_waitcnt lgkmcnt(6)
    v_mfma_f32_16x16x32_bf16 v[220:223], v[176:179], v[48:51], v[220:223]
    v_mfma_f32_16x16x32_bf16 v[224:227], v[176:179], v[64:67], v[224:227]
    s_waitcnt lgkmcnt(5)
    v_mfma_f32_16x16x32_bf16 v[220:223], v[180:183], v[52:55], v[220:223]
    v_mfma_f32_16x16x32_bf16 v[224:227], v[180:183], v[68:71], v[224:227]
    s_waitcnt lgkmcnt(4)
    v_mfma_f32_16x16x32_bf16 v[220:223], v[184:187], v[56:59], v[220:223]
    v_mfma_f32_16x16x32_bf16 v[224:227], v[184:187], v[72:75], v[224:227]
    s_waitcnt lgkmcnt(3)
    v_mfma_f32_16x16x32_bf16 v[228:231], v[188:191], v[44:47], 0
    v_mfma_f32_16x16x32_bf16 v[232:235], v[188:191], v[60:63], 0
    s_waitcnt lgkmcnt(2)
    v_mfma_f32_16x16x32_bf16 v[228:231], v[192:195], v[48:51], v[228:231]
    v_mfma_f32_16x16x32_bf16 v[232:235], v[192:195], v[64:67], v[232:235]
    s_waitcnt lgkmcnt(1)
    v_mfma_f32_16x16x32_bf16 v[228:231], v[196:199], v[52:55], v[228:231]
    v_mfma_f32_16x16x32_bf16 v[232:235], v[196:199], v[68:71], v[232:235]
    s_waitcnt lgkmcnt(0)
    v_mfma_f32_16x16x32_bf16 v[228:231], v[200:203], v[56:59], v[228:231]
    v_mfma_f32_16x16x32_bf16 v[232:235], v[200:203], v[72:75], v[232:235]
    s_nop 7
    s_cmp_eq_u32 s62, 0x1010
    s_cbranch_scc0 L_maskF
L_nomaskF:
    v_max3_f32 v33, v220, v221, v222
    v_max3_f32 v34, v224, v225, v226
    v_max3_f32 v33, v33, v223, v228
    v_max3_f32 v34, v34, v227, v232
    v_max3_f32 v33, v33, v229, v230
    v_max3_f32 v34, v34, v233, v234
    v_max_f32 v33, v33, v231
    v_max_f32 v34, v34, v235
    s_nop 1
    v_permlane32_swap_b32 v33, v34
    s_nop 0
    v_max_f32 v35, v33, v34
    v_max_f32 v36, v33, v34
    s_nop 1
    v_permlane16_swap_b32 v36, v35
    s_nop 0
    v_max_f32 v35, v36, v35
    v_mul_f32 v28, s55, v35
    v_mul_f32 v31, s55, v35
    v_mul_f32 v32, s55, v35
    s_nop 1
    v_permlane32_swap_b32 v31, v32
    s_nop 0
    v_fma_f32 v220, v220, s55, -v31
    v_fma_f32 v221, v221, s55, -v31
    v_fma_f32 v222, v222, s55, -v31
    v_fma_f32 v223, v223, s55, -v31
    v_fma_f32 v224, v224, s55, -v32
    v_fma_f32 v225, v225, s55, -v32
    v_fma_f32 v226, v226, s55, -v32
    v_fma_f32 v227, v227, s55, -v32
    v_fma_f32 v228, v228, s55, -v31
    v_fma_f32 v229, v229, s55, -v31
    v_fma_f32 v230, v230, s55, -v31
    v_fma_f32 v231, v231, s55, -v31
    v_fma_f32 v232, v232, s55, -v32
    v_fma_f32 v233, v233, s55, -v32
    v_fma_f32 v234, v234, s55, -v32
    v_fma_f32 v235, v235, s55, -v32
    v_exp_f32 v220, v220
    v_exp_f32 v221, v221
    v_exp_f32 v222, v222
    v_exp_f32 v223, v223
    v_exp_f32 v224, v224
    v_exp_f32 v225, v225
    v_exp_f32 v226, v226
    v_exp_f32 v227, v227
    v_exp_f32 v228, v228
    v_exp_f32 v229, v229
    v_exp_f32 v230, v230
    v_exp_f32 v231, v231
    v_exp_f32 v232, v232
    v_exp_f32 v233, v233
    v_exp_f32 v234, v234
    v_exp_f32 v235, v235
    s_add_u32 m0, s57, 24576
    s_waitcnt vmcnt(4)
    buffer_load_dwordx4 v12, s[24:27], s85 offen nt lds
    buffer_load_dwordx4 v13, s[24:27], s85 offen offset:1024 nt lds
    ds_read_b64_tr_b16 v[204:205], v20 offset:8192
    ds_read_b64_tr_b16 v[206:207], v20 offset:12288
    ds_read_b64_tr_b16 v[208:209], v21 offset:8192
    ds_read_b64_tr_b16 v[210:211], v21 offset:12288
    ds_read_b64_tr_b16 v[212:213], v22 offset:8192
    ds_read_b64_tr_b16 v[214:215], v22 offset:12288
    ds_read_b64_tr_b16 v[216:217], v23 offset:8192
    ds_read_b64_tr_b16 v[218:219], v23 offset:12288
    v_cvt_pk_bf16_f32 v236, v220, v221
    v_cvt_pk_bf16_f32 v237, v222, v223
    v_cvt_pk_bf16_f32 v238, v228, v229
    v_cvt_pk_bf16_f32 v239, v230, v231
    v_cvt_pk_bf16_f32 v240, v224, v225
    v_cvt_pk_bf16_f32 v241, v226, v227
    v_cvt_pk_bf16_f32 v242, v232, v233
    v_cvt_pk_bf16_f32 v243, v234, v235
    v_add_f32 v220, v220, v221
    v_add_f32 v222, v222, v223
    v_add_f32 v228, v228, v229
    v_add_f32 v230, v230, v231
    v_add_f32 v220, v220, v222
    v_add_f32 v228, v228, v230
    v_add_f32 v29, v220, v228
    v_add_f32 v224, v224, v225
    v_add_f32 v226, v226, v227
    v_add_f32 v232, v232, v233
    v_add_f32 v234, v234, v235
    v_add_f32 v224, v224, v226
    v_add_f32 v232, v232, v234
    v_add_f32 v30, v224, v232
    s_waitcnt lgkmcnt(6)
    v_mfma_f32_16x16x32_bf16 v[108:111], v[204:207], v[236:239], 0
    v_mfma_f32_16x16x32_bf16 v[140:143], v[204:207], v[240:243], 0
    s_waitcnt lgkmcnt(4)
    v_mfma_f32_16x16x32_bf16 v[112:115], v[208:211], v[236:239], 0
    v_mfma_f32_16x16x32_bf16 v[144:147], v[208:211], v[240:243], 0
    ds_read_b64_tr_b16 v[204:205], v24 offset:8192
    ds_read_b64_tr_b16 v[206:207], v24 offset:12288
    ds_read_b64_tr_b16 v[208:209], v25 offset:8192
    ds_read_b64_tr_b16 v[210:211], v25 offset:12288
    s_waitcnt vmcnt(4)
    buffer_load_dwordx4 v14, s[24:27], s85 offen offset:2048 nt lds
    buffer_load_dwordx4 v15, s[24:27], s85 offen offset:3072 nt lds
    s_waitcnt lgkmcnt(6)
    v_mfma_f32_16x16x32_bf16 v[116:119], v[212:215], v[236:239], 0
    v_mfma_f32_16x16x32_bf16 v[148:151], v[212:215], v[240:243], 0
    s_waitcnt lgkmcnt(4)
    v_mfma_f32_16x16x32_bf16 v[120:123], v[216:219], v[236:239], 0
    v_mfma_f32_16x16x32_bf16 v[152:155], v[216:219], v[240:243], 0
    ds_read_b64_tr_b16 v[212:213], v26 offset:8192
    ds_read_b64_tr_b16 v[214:215], v26 offset:12288
    ds_read_b64_tr_b16 v[216:217], v27 offset:8192
    ds_read_b64_tr_b16 v[218:219], v27 offset:12288
    s_add_u32 m0, s57, 28672
    s_waitcnt vmcnt(4)
    buffer_load_dwordx4 v12, s[24:27], s86 offen nt lds
    buffer_load_dwordx4 v13, s[24:27], s86 offen offset:1024 nt lds
    s_waitcnt lgkmcnt(6)
    v_mfma_f32_16x16x32_bf16 v[124:127], v[204:207], v[236:239], 0
    v_mfma_f32_16x16x32_bf16 v[156:159], v[204:207], v[240:243], 0
    s_waitcnt lgkmcnt(4)
    v_mfma_f32_16x16x32_bf16 v[128:131], v[208:211], v[236:239], 0
    v_mfma_f32_16x16x32_bf16 v[160:163], v[208:211], v[240:243], 0
    s_waitcnt vmcnt(4)
    buffer_load_dwordx4 v14, s[24:27], s86 offen offset:2048 nt lds
    buffer_load_dwordx4 v15, s[24:27], s86 offen offset:3072 nt lds
    s_waitcnt lgkmcnt(2)
    v_mfma_f32_16x16x32_bf16 v[132:135], v[212:215], v[236:239], 0
    v_mfma_f32_16x16x32_bf16 v[164:167], v[212:215], v[240:243], 0
    s_waitcnt lgkmcnt(0)
    v_mfma_f32_16x16x32_bf16 v[136:139], v[216:219], v[236:239], 0
    v_mfma_f32_16x16x32_bf16 v[168:171], v[216:219], v[240:243], 0
    v_xor_b32 v16, 0x4000, v16
    v_xor_b32 v17, 0x4000, v17
    v_xor_b32 v18, 0x4000, v18
    v_xor_b32 v19, 0x4000, v19
    v_xor_b32 v20, 0x4000, v20
    v_xor_b32 v21, 0x4000, v21
    v_xor_b32 v22, 0x4000, v22
    v_xor_b32 v23, 0x4000, v23
    v_xor_b32 v24, 0x4000, v24
    v_xor_b32 v25, 0x4000, v25
    v_xor_b32 v26, 0x4000, v26
    v_xor_b32 v27, 0x4000, v27
    s_sub_u32 s59, s59, 1
    s_cmp_lg_u32 s59, 0
    s_cbranch_scc0 L_exit
L_loop:
    s_cmp_lg_u32 s76, 0
    s_cbranch_scc1 L_loopN
    s_cmp_eq_u32 s59, 1
    s_cbranch_scc1 L_loopZ
    s_cmp_le_u32 s59, 2
    s_cbranch_scc1 L_loopF2
    s_cmp_le_u32 s59, s73
    s_cbranch_scc1 L_loopD
    s_sub_u32 s59, s59, s73
    s_mov_b32 s76, 4
L_loopN:
    s_cmp_eq_u32 s76, 3
    s_cbranch_scc1 L_loopP
    s_cmp_eq_u32 s83, 1
    s_cbranch_scc1 L_loopB
    s_cmp_eq_u32 s83, 2
    s_cbranch_scc1 L_loopQ
    s_cmp_eq_u32 s83, 3
    s_cbranch_scc1 L_loopS
.p2align 6
L_loopA:
    v_readlane_b32 s60, v8, s58
    v_readlane_b32 s61, v9, s58
    s_sub_u32 s63, s58, 1
    v_readlane_b32 s62, v10, s63
    s_add_u32 s58, s58, 1
    s_waitcnt vmcnt(4)
    ds_read_b128 v[172:175], v16
    ds_read_b128 v[176:179], v17
    ds_read_b128 v[180:183], v18
    ds_read_b128 v[184:187], v19
    ds_read_b128 v[188:191], v16 offset:4096
    ds_read_b128 v[192:195], v17 offset:4096
    ds_read_b128 v[196:199], v18 offset:4096
    ds_read_b128 v[200:203], v19 offset:4096
    s_mov_b32 m0, s57
    s_waitcnt vmcnt(4)
    buffer_load_dwordx4 v12, s[20:23], s60 offen nt lds
    buffer_load_dwordx4 v13, s[20:23], s60 offen offset:1024 nt lds
    s_waitcnt lgkmcnt(7)
    v_mfma_f32_16x16x32_bf16 v[220:223], v[172:175], v[44:47], 0
    v_mfma_f32_16x16x32_bf16 v[224:227], v[172:175], v[60:63], 0
    s_waitcnt lgkmcnt(6)
    v_mfma_f32_16x16x32_bf16 v[220:223], v[176:179], v[48:51], v[220:223]
    v_mfma_f32_16x16x32_bf16 v[224:227], v[176:179], v[64:67], v[224:227]
    s_waitcnt lgkmcnt(5)
    v_mfma_f32_16x16x32_bf16 v[220:223], v[180:183], v[52:55], v[220:223]
    v_mfma_f32_16x16x32_bf16 v[224:227], v[180:183], v[68:71], v[224:227]
    s_waitcnt lgkmcnt(4)
    v_mfma_f32_16x16x32_bf16 v[220:223], v[184:187], v[56:59], v[220:223]
    v_mfma_f32_16x16x32_bf16 v[224:227], v[184:187], v[72:75], v[224:227]
    s_waitcnt vmcnt(4)
    buffer_load_dwordx4 v14, s[20:23], s60 offen offset:2048 nt lds
    buffer_load_dwordx4 v15, s[20:23], s60 offen offset:3072 nt lds
    s_waitcnt lgkmcnt(3)
    v_mfma_f32_16x16x32_bf16 v[228:231], v[188:191], v[44:47], 0
    v_mfma_f32_16x16x32_bf16 v[232:235], v[188:191], v[60:63], 0
    s_waitcnt lgkmcnt(2)
    v_mfma_f32_16x16x32_bf16 v[228:231], v[192:195], v[48:51], v[228:231]
    v_mfma_f32_16x16x32_bf16 v[232:235], v[192:195], v[64:67], v[232:235]
    s_waitcnt lgkmcnt(1)
    v_mfma_f32_16x16x32_bf16 v[228:231], v[196:199], v[52:55], v[228:231]
    v_mfma_f32_16x16x32_bf16 v[232:235], v[196:199], v[68:71], v[232:235]
    s_waitcnt lgkmcnt(0)
    v_mfma_f32_16x16x32_bf16 v[228:231], v[200:203], v[56:59], v[228:231]
    v_mfma_f32_16x16x32_bf16 v[232:235], v[200:203], v[72:75], v[232:235]
    s_add_u32 m0, s57, 4096
    s_waitcnt vmcnt(4)
    buffer_load_dwordx4 v12, s[20:23], s61 offen nt lds
    buffer_load_dwordx4 v13, s[20:23], s61 offen offset:1024 nt lds
    s_nop 3
    s_cmp_eq_u32 s62, 0x1010
    s_cbranch_scc0 L_maskA
L_nomaskA:
    v_max3_f32 v33, v220, v221, v222
    v_max3_f32 v34, v224, v225, v226
    v_max3_f32 v33, v33, v223, v228
    v_max3_f32 v34, v34, v227, v232
    v_max3_f32 v33, v33, v229, v230
    v_max3_f32 v34, v34, v233, v234
    v_max_f32 v33, v33, v231
    v_max_f32 v34, v34, v235
    s_nop 1
    v_permlane32_swap_b32 v33, v34
    s_nop 0
    v_max_f32 v35, v33, v34
    v_max_f32 v36, v33, v34
    s_nop 1
    v_permlane16_swap_b32 v36, v35
    s_nop 0
    v_max_f32 v35, v36, v35
    v_mul_f32 v35, s55, v35
    v_max_f32 v31, v28, v35
    v_max_f32 v32, v28, v35
    v_cmp_gt_f32 vcc, v31, v28
    v_sub_f32 v37, v28, v31
    v_mov_b32 v28, v31
    v_permlane32_swap_b32 v31, v32
    s_cbranch_vccz L_norescaleA
    v_exp_f32 v38, v37
    v_exp_f32 v39, v37
    s_nop 1
    v_permlane32_swap_b32 v38, v39
    s_nop 0
    v_mul_f32 v29, v29, v38
    v_mul_f32 v30, v30, v39
    v_mul_f32 v108, v108, v38
    v_mul_f32 v109, v109, v38
    v_mul_f32 v110, v110, v38
    v_mul_f32 v111, v111, v38
    v_mul_f32 v112, v112, v38
    v_mul_f32 v113, v113, v38
    v_mul_f32 v114, v114, v38
    v_mul_f32 v115, v115, v38
    v_mul_f32 v116, v116, v38
    v_mul_f32 v117, v117, v38
    v_mul_f32 v118, v118, v38
    v_mul_f32 v119, v119, v38
    v_mul_f32 v120, v120, v38
    v_mul_f32 v121, v121, v38
    v_mul_f32 v122, v122, v38
    v_mul_f32 v123, v123, v38
    v_mul_f32 v124, v124, v38
    v_mul_f32 v125, v125, v38
    v_mul_f32 v126, v126, v38
    v_mul_f32 v127, v127, v38
    v_mul_f32 v128, v128, v38
    v_mul_f32 v129, v129, v38
    v_mul_f32 v130, v130, v38
    v_mul_f32 v131, v131, v38
    v_mul_f32 v132, v132, v38
    v_mul_f32 v133, v133, v38
    v_mul_f32 v134, v134, v38
    v_mul_f32 v135, v135, v38
    v_mul_f32 v136, v136, v38
    v_mul_f32 v137, v137, v38
    v_mul_f32 v138, v138, v38
    v_mul_f32 v139, v139, v38
    v_mul_f32 v140, v140, v39
    v_mul_f32 v141, v141, v39
    v_mul_f32 v142, v142, v39
    v_mul_f32 v143, v143, v39
    v_mul_f32 v144, v144, v39
    v_mul_f32 v145, v145, v39
    v_mul_f32 v146, v146, v39
    v_mul_f32 v147, v147, v39
    v_mul_f32 v148, v148, v39
    v_mul_f32 v149, v149, v39
    v_mul_f32 v150, v150, v39
    v_mul_f32 v151, v151, v39
    v_mul_f32 v152, v152, v39
    v_mul_f32 v153, v153, v39
    v_mul_f32 v154, v154, v39
    v_mul_f32 v155, v155, v39
    v_mul_f32 v156, v156, v39
    v_mul_f32 v157, v157, v39
    v_mul_f32 v158, v158, v39
    v_mul_f32 v159, v159, v39
    v_mul_f32 v160, v160, v39
    v_mul_f32 v161, v161, v39
    v_mul_f32 v162, v162, v39
    v_mul_f32 v163, v163, v39
    v_mul_f32 v164, v164, v39
    v_mul_f32 v165, v165, v39
    v_mul_f32 v166, v166, v39
    v_mul_f32 v167, v167, v39
    v_mul_f32 v168, v168, v39
    v_mul_f32 v169, v169, v39
    v_mul_f32 v170, v170, v39
    v_mul_f32 v171, v171, v39
L_norescaleA:
    s_waitcnt vmcnt(3)
    buffer_load_dwordx4 v14, s[20:23], s61 offen offset:2048 nt lds
    buffer_load_dwordx4 v15, s[20:23], s61 offen offset:3072 nt lds
    v_fma_f32 v220, v220, s55, -v31
    v_fma_f32 v221, v221, s55, -v31
    v_fma_f32 v222, v222, s55, -v31
    v_fma_f32 v223, v223, s55, -v31
    v_fma_f32 v224, v224, s55, -v32
    v_fma_f32 v225, v225, s55, -v32
    v_fma_f32 v226, v226, s55, -v32
    v_fma_f32 v227, v227, s55, -v32
    v_fma_f32 v228, v228, s55, -v31
    v_fma_f32 v229, v229, s55, -v31
    v_fma_f32 v230, v230, s55, -v31
    v_fma_f32 v231, v231, s55, -v31
    v_fma_f32 v232, v232, s55, -v32
    v_fma_f32 v233, v233, s55, -v32
    v_fma_f32 v234, v234, s55, -v32
    v_fma_f32 v235, v235, s55, -v32
    v_exp_f32 v220, v220
    v_exp_f32 v221, v221
    v_exp_f32 v222, v222
    v_exp_f32 v223, v223
    v_exp_f32 v224, v224
    v_exp_f32 v225, v225
    v_exp_f32 v226, v226
    v_exp_f32 v227, v227
    v_exp_f32 v228, v228
    v_exp_f32 v229, v229
    v_exp_f32 v230, v230
    v_exp_f32 v231, v231
    v_exp_f32 v232, v232
    v_exp_f32 v233, v233
    v_exp_f32 v234, v234
    v_exp_f32 v235, v235
    s_add_u32 m0, s57, 8192
    s_waitcnt vmcnt(4)
    buffer_load_dwordx4 v12, s[24:27], s60 offen nt lds
    buffer_load_dwordx4 v13, s[24:27], s60 offen offset:1024 nt lds
    ds_read_b64_tr_b16 v[204:205], v20 offset:8192
    ds_read_b64_tr_b16 v[206:207], v20 offset:12288
    ds_read_b64_tr_b16 v[208:209], v21 offset:8192
    ds_read_b64_tr_b16 v[210:211], v21 offset:12288
    ds_read_b64_tr_b16 v[212:213], v22 offset:8192
    ds_read_b64_tr_b16 v[214:215], v22 offset:12288
    ds_read_b64_tr_b16 v[216:217], v23 offset:8192
    ds_read_b64_tr_b16 v[218:219], v23 offset:12288
    v_cvt_pk_bf16_f32 v236, v220, v221
    v_cvt_pk_bf16_f32 v237, v222, v223
    v_cvt_pk_bf16_f32 v238, v228, v229
    v_cvt_pk_bf16_f32 v239, v230, v231
    v_cvt_pk_bf16_f32 v240, v224, v225
    v_cvt_pk_bf16_f32 v241, v226, v227
    v_cvt_pk_bf16_f32 v242, v232, v233
    v_cvt_pk_bf16_f32 v243, v234, v235
    v_add_f32 v220, v220, v221
    v_add_f32 v222, v222, v223
    v_add_f32 v228, v228, v229
    v_add_f32 v230, v230, v231
    v_add_f32 v220, v220, v222
    v_add_f32 v228, v228, v230
    v_add_f32 v29, v29, v220
    v_add_f32 v29, v29, v228
    v_add_f32 v224, v224, v225
    v_add_f32 v226, v226, v227
    v_add_f32 v232, v232, v233
    v_add_f32 v234, v234, v235
    v_add_f32 v224, v224, v226
    v_add_f32 v232, v232, v234
    v_add_f32 v30, v30, v224
    v_add_f32 v30, v30, v232
    s_waitcnt lgkmcnt(6)
    v_mfma_f32_16x16x32_bf16 v[108:111], v[204:207], v[236:239], v[108:111]
    v_mfma_f32_16x16x32_bf16 v[140:143], v[204:207], v[240:243], v[140:143]
    s_waitcnt lgkmcnt(4)
    v_mfma_f32_16x16x32_bf16 v[112:115], v[208:211], v[236:239], v[112:115]
    v_mfma_f32_16x16x32_bf16 v[144:147], v[208:211], v[240:243], v[144:147]
    ds_read_b64_tr_b16 v[204:205], v24 offset:8192
    ds_read_b64_tr_b16 v[206:207], v24 offset:12288
    ds_read_b64_tr_b16 v[208:209], v25 offset:8192
    ds_read_b64_tr_b16 v[210:211], v25 offset:12288
    s_waitcnt vmcnt(4)
    buffer_load_dwordx4 v14, s[24:27], s60 offen offset:2048 nt lds
    buffer_load_dwordx4 v15, s[24:27], s60 offen offset:3072 nt lds
    s_waitcnt lgkmcnt(6)
    v_mfma_f32_16x16x32_bf16 v[116:119], v[212:215], v[236:239], v[116:119]
    v_mfma_f32_16x16x32_bf16 v[148:151], v[212:215], v[240:243], v[148:151]
    s_waitcnt lgkmcnt(4)
    v_mfma_f32_16x16x32_bf16 v[120:123], v[216:219], v[236:239], v[120:123]
    v_mfma_f32_16x16x32_bf16 v[152:155], v[216:219], v[240:243], v[152:155]
    ds_read_b64_tr_b16 v[212:213], v26 offset:8192
    ds_read_b64_tr_b16 v[214:215], v26 offset:12288
    ds_read_b64_tr_b16 v[216:217], v27 offset:8192
    ds_read_b64_tr_b16 v[218:219], v27 offset:12288
    s_add_u32 m0, s57, 12288
    s_waitcnt vmcnt(4)
    buffer_load_dwordx4 v12, s[24:27], s61 offen nt lds
    buffer_load_dwordx4 v13, s[24:27], s61 offen offset:1024 nt lds
    s_waitcnt lgkmcnt(6)
    v_mfma_f32_16x16x32_bf16 v[124:127], v[204:207], v[236:239], v[124:127]
    v_mfma_f32_16x16x32_bf16 v[156:159], v[204:207], v[240:243], v[156:159]
    s_waitcnt lgkmcnt(4)
    v_mfma_f32_16x16x32_bf16 v[128:131], v[208:211], v[236:239], v[128:131]
    v_mfma_f32_16x16x32_bf16 v[160:163], v[208:211], v[240:243], v[160:163]
    s_waitcnt vmcnt(4)
    buffer_load_dwordx4 v14, s[24:27], s61 offen offset:2048 nt lds
    buffer_load_dwordx4 v15, s[24:27], s61 offen offset:3072 nt lds
    s_waitcnt lgkmcnt(2)
    v_mfma_f32_16x16x32_bf16 v[132:135], v[212:215], v[236:239], v[132:135]
    v_mfma_f32_16x16x32_bf16 v[164:167], v[212:215], v[240:243], v[164:167]
    s_waitcnt lgkmcnt(0)
    v_mfma_f32_16x16x32_bf16 v[136:139], v[216:219], v[236:239], v[136:139]
    v_mfma_f32_16x16x32_bf16 v[168:171], v[216:219], v[240:243], v[168:171]
    v_xor_b32 v16, 0x4000, v16
    v_xor_b32 v17, 0x4000, v17
    v_xor_b32 v18, 0x4000, v18
    v_xor_b32 v19, 0x4000, v19
    v_xor_b32 v20, 0x4000, v20
    v_xor_b32 v21, 0x4000, v21
    v_xor_b32 v22, 0x4000, v22
    v_xor_b32 v23, 0x4000, v23
    v_xor_b32 v24, 0x4000, v24
    v_xor_b32 v25, 0x4000, v25
    v_xor_b32 v26, 0x4000, v26
    v_xor_b32 v27, 0x4000, v27
    s_xor_b32 s57, s57, 0x4000
    s_sub_u32 s59, s59, 1
    s_cmp_lg_u32 s59, 0
    s_cbranch_scc1 L_loopA
    s_branch L_exit
.p2align 6
L_loopQ:
    v_readlane_b32 s60, v8, s58
    v_readlane_b32 s61, v9, s58
    s_sub_u32 s63, s58, 1
    v_readlane_b32 s62, v10, s63
    s_add_u32 s58, s58, 1
    s_waitcnt vmcnt(4)
    ds_read_b128 v[172:175], v16
    ds_read_b128 v[176:179], v17
    ds_read_b128 v[180:183], v18
    ds_read_b128 v[184:187], v19
    ds_read_b128 v[188:191], v16 offset:4096
    ds_read_b128 v[192:195], v17 offset:4096
    ds_read_b128 v[196:199], v18 offset:4096
    ds_read_b128 v[200:203], v19 offset:4096
    s_mov_b32 m0, s57
    s_waitcnt vmcnt(4)
    buffer_load_dwordx4 v12, s[20:23], s60 offen nt lds
    buffer_load_dwordx4 v13, s[20:23], s60 offen offset:1024 nt lds
    s_waitcnt lgkmcnt(7)
    v_mfma_f32_16x16x32_bf16 v[220:223], v[172:175], v[44:47], 0
    v_mfma_f32_16x16x32_bf16 v[224:227], v[172:175], v[60:63], 0
    s_waitcnt lgkmcnt(6)
    v_mfma_f32_16x16x32_bf16 v[220:223], v[176:179], v[48:51], v[220:223]
    v_mfma_f32_16x16x32_bf16 v[224:227], v[176:179], v[64:67], v[224:227]
    s_waitcnt lgkmcnt(5)
    v_mfma_f32_16x16x32_bf16 v[220:223], v[180:183], v[52:55], v[220:223]
    v_mfma_f32_16x16x32_bf16 v[224:227], v[180:183], v[68:71], v[224:227]
    s_waitcnt lgkmcnt(4)
    v_mfma_f32_16x16x32_bf16 v[220:223], v[184:187], v[56:59], v[220:223]
    v_mfma_f32_16x16x32_bf16 v[224:227], v[184:187], v[72:75], v[224:227]
    s_waitcnt vmcnt(4)
    buffer_load_dwordx4 v14, s[20:23], s60 offen offset:2048 nt lds
    buffer_load_dwordx4 v15, s[20:23], s60 offen offset:3072 nt lds
    s_waitcnt lgkmcnt(3)
    v_mfma_f32_16x16x32_bf16 v[228:231], v[188:191], v[44:47], 0
    v_mfma_f32_16x16x32_bf16 v[232:235], v[188:191], v[60:63], 0
    s_waitcnt lgkmcnt(2)
    v_mfma_f32_16x16x32_bf16 v[228:231], v[192:195], v[48:51], v[228:231]
    v_mfma_f32_16x16x32_bf16 v[232:235], v[192:195], v[64:67], v[232:235]
    s_waitcnt lgkmcnt(1)
    v_mfma_f32_16x16x32_bf16 v[228:231], v[196:199], v[52:55], v[228:231]
    v_mfma_f32_16x16x32_bf16 v[232:235], v[196:199], v[68:71], v[232:235]
    s_waitcnt lgkmcnt(0)
    v_mfma_f32_16x16x32_bf16 v[228:231], v[200:203], v[56:59], v[228:231]
    v_mfma_f32_16x16x32_bf16 v[232:235], v[200:203], v[72:75], v[232:235]
    s_add_u32 m0, s57, 4096
    s_waitcnt vmcnt(4)
    buffer_load_dwordx4 v12, s[20:23], s61 offen nt lds
    buffer_load_dwordx4 v13, s[20:23], s61 offen offset:1024 nt lds
    s_nop 3
    s_cmp_eq_u32 s62, 0x1010
    s_cbranch_scc0 L_maskQ
L_nomaskQ:
    v_max3_f32 v33, v220, v221, v222
    v_max3_f32 v34, v224, v225, v226
    v_max3_f32 v33, v33, v223, v228
    v_max3_f32 v34, v34, v227, v232
    v_max3_f32 v33, v33, v229, v230
    v_max3_f32 v34, v34, v233, v234
    v_max_f32 v33, v33, v231
    v_max_f32 v34, v34, v235
    s_nop 1
    v_permlane32_swap_b32 v33, v34
    s_nop 0
    v_max_f32 v35, v33, v34
    v_max_f32 v36, v33, v34
    s_nop 1
    v_permlane16_swap_b32 v36, v35
    s_nop 0
    v_max_f32 v35, v36, v35
    v_mul_f32 v35, s55, v35
    v_max_f32 v31, v28, v35
    v_max_f32 v32, v28, v35
    v_cmp_gt_f32 vcc, v31, v28
    v_sub_f32 v37, v28, v31
    v_mov_b32 v28, v31
    v_permlane32_swap_b32 v31, v32
    s_cbranch_vccz L_norescaleQ
    v_exp_f32 v38, v37
    v_exp_f32 v39, v37
    s_nop 1
    v_permlane32_swap_b32 v38, v39
    s_nop 0
    v_mul_f32 v29, v29, v38
    v_mul_f32 v30, v30, v39
    v_mul_f32 v108, v108, v38
    v_mul_f32 v109, v109, v38
    v_mul_f32 v110, v110, v38
    v_mul_f32 v111, v111, v38
    v_mul_f32 v112, v112, v38
    v_mul_f32 v113, v113, v38
    v_mul_f32 v114, v114, v38
    v_mul_f32 v115, v115, v38
    v_mul_f32 v116, v116, v38
    v_mul_f32 v117, v117, v38
    v_mul_f32 v118, v118, v38
    v_mul_f32 v119, v119, v38
    v_mul_f32 v120, v120, v38
    v_mul_f32 v121, v121, v38
    v_mul_f32 v122, v122, v38
    v_mul_f32 v123, v123, v38
    v_mul_f32 v124, v124, v38
    v_mul_f32 v125, v125, v38
    v_mul_f32 v126, v126, v38
    v_mul_f32 v127, v127, v38
    v_mul_f32 v128, v128, v38
    v_mul_f32 v129, v129, v38
    v_mul_f32 v130, v130, v38
    v_mul_f32 v131, v131, v38
    v_mul_f32 v132, v132, v38
    v_mul_f32 v133, v133, v38
    v_mul_f32 v134, v134, v38
    v_mul_f32 v135, v135, v38
    v_mul_f32 v136, v136, v38
    v_mul_f32 v137, v137, v38
    v_mul_f32 v138, v138, v38
    v_mul_f32 v139, v139, v38
    v_mul_f32 v140, v140, v39
    v_mul_f32 v141, v141, v39
    v_mul_f32 v142, v142, v39
    v_mul_f32 v143, v143, v39
    v_mul_f32 v144, v144, v39
    v_mul_f32 v145, v145, v39
    v_mul_f32 v146, v146, v39
    v_mul_f32 v147, v147, v39
    v_mul_f32 v148, v148, v39
    v_mul_f32 v149, v149, v39
    v_mul_f32 v150, v150, v39
    v_mul_f32 v151, v151, v39
    v_mul_f32 v152, v152, v39
    v_mul_f32 v153, v153, v39
    v_mul_f32 v154, v154, v39
    v_mul_f32 v155, v155, v39
    v_mul_f32 v156, v156, v39
    v_mul_f32 v157, v157, v39
    v_mul_f32 v158, v158, v39
    v_mul_f32 v159, v159, v39
    v_mul_f32 v160, v160, v39
    v_mul_f32 v161, v161, v39
    v_mul_f32 v162, v162, v39
    v_mul_f32 v163, v163, v39
    v_mul_f32 v164, v164, v39
    v_mul_f32 v165, v165, v39
    v_mul_f32 v166, v166, v39
    v_mul_f32 v167, v167, v39
    v_mul_f32 v168, v168, v39
    v_mul_f32 v169, v169, v39
    v_mul_f32 v170, v170, v39
    v_mul_f32 v171, v171, v39
L_norescaleQ:
    s_waitcnt vmcnt(4)
    buffer_load_dwordx4 v14, s[20:23], s61 offen offset:2048 nt lds
    buffer_load_dwordx4 v15, s[20:23], s61 offen offset:3072 nt lds
    v_fma_f32 v220, v220, s55, -v31
    v_fma_f32 v221, v221, s55, -v31
    v_fma_f32 v222, v222, s55, -v31
    v_fma_f32 v223, v223, s55, -v31
    v_fma_f32 v224, v224, s55, -v32
    v_fma_f32 v225, v225, s55, -v32
    v_fma_f32 v226, v226, s55, -v32
    v_fma_f32 v227, v227, s55, -v32
    v_fma_f32 v228, v228, s55, -v31
    v_fma_f32 v229, v229, s55, -v31
    v_fma_f32 v230, v230, s55, -v31
    v_fma_f32 v231, v231, s55, -v31
    v_fma_f32 v232, v232, s55, -v32
    v_fma_f32 v233, v233, s55, -v32
    v_fma_f32 v234, v234, s55, -v32
    v_fma_f32 v235, v235, s55, -v32
    v_exp_f32 v220, v220
    v_exp_f32 v221, v221
    v_exp_f32 v222, v222
    v_exp_f32 v223, v223
    v_exp_f32 v224, v224
    v_exp_f32 v225, v225
    v_exp_f32 v226, v226
    v_exp_f32 v227, v227
    v_exp_f32 v228, v228
    v_exp_f32 v229, v229
    v_exp_f32 v230, v230
    v_exp_f32 v231, v231
    v_exp_f32 v232, v232
    v_exp_f32 v233, v233
    v_exp_f32 v234, v234
    v_exp_f32 v235, v235
    s_add_u32 m0, s57, 8192
    s_waitcnt vmcnt(4)
    buffer_load_dwordx4 v12, s[24:27], s60 offen nt lds
    buffer_load_dwordx4 v13, s[24:27], s60 offen offset:1024 nt lds
    ds_read_b64_tr_b16 v[204:205], v20 offset:8192
    ds_read_b64_tr_b16 v[206:207], v20 offset:12288
    ds_read_b64_tr_b16 v[208:209], v21 offset:8192
    ds_read_b64_tr_b16 v[210:211], v21 offset:12288
    ds_read_b64_tr_b16 v[212:213], v22 offset:8192
    ds_read_b64_tr_b16 v[214:215], v22 offset:12288
    ds_read_b64_tr_b16 v[216:217], v23 offset:8192
    ds_read_b64_tr_b16 v[218:219], v23 offset:12288
    v_cvt_pk_bf16_f32 v236, v220, v221
    v_cvt_pk_bf16_f32 v237, v222, v223
    v_cvt_pk_bf16_f32 v238, v228, v229
    v_cvt_pk_bf16_f32 v239, v230, v231
    v_cvt_pk_bf16_f32 v240, v224, v225
    v_cvt_pk_bf16_f32 v241, v226, v227
    v_cvt_pk_bf16_f32 v242, v232, v233
    v_cvt_pk_bf16_f32 v243, v234, v235
    v_add_f32 v220, v220, v221
    v_add_f32 v222, v222, v223
    v_add_f32 v228, v228, v229
    v_add_f32 v230, v230, v231
    v_add_f32 v220, v220, v222
    v_add_f32 v228, v228, v230
    v_add_f32 v29, v29, v220
    v_add_f32 v29, v29, v228
    v_add_f32 v224, v224, v225
    v_add_f32 v226, v226, v227
    v_add_f32 v232, v232, v233
    v_add_f32 v234, v234, v235
    v_add_f32 v224, v224, v226
    v_add_f32 v232, v232, v234
    v_add_f32 v30, v30, v224
    v_add_f32 v30, v30, v232
    s_waitcnt lgkmcnt(6)
    v_mfma_f32_16x16x32_bf16 v[108:111], v[204:207], v[236:239], v[108:111]
    v_mfma_f32_16x16x32_bf16 v[140:143], v[204:207], v[240:243], v[140:143]
    s_waitcnt lgkmcnt(4)
    v_mfma_f32_16x16x32_bf16 v[112:115], v[208:211], v[236:239], v[112:115]
    v_mfma_f32_16x16x32_bf16 v[144:147], v[208:211], v[240:243], v[144:147]
    ds_read_b64_tr_b16 v[204:205], v24 offset:8192
    ds_read_b64_tr_b16 v[206:207], v24 offset:12288
    ds_read_b64_tr_b16 v[208:209], v25 offset:8192
    ds_read_b64_tr_b16 v[210:211], v25 offset:12288
    s_waitcnt vmcnt(5)
    buffer_load_dwordx4 v14, s[24:27], s60 offen offset:2048 nt lds
    buffer_load_dwordx4 v15, s[24:27], s60 offen offset:3072 nt lds
    s_waitcnt lgkmcnt(6)
    v_mfma_f32_16x16x32_bf16 v[116:119], v[212:215], v[236:239], v[116:119]
    v_mfma_f32_16x16x32_bf16 v[148:151], v[212:215], v[240:243], v[148:151]
    s_waitcnt lgkmcnt(4)
    v_mfma_f32_16x16x32_bf16 v[120:123], v[216:219], v[236:239], v[120:123]
    v_mfma_f32_16x16x32_bf16 v[152:155], v[216:219], v[240:243], v[152:155]
    ds_read_b64_tr_b16 v[212:213], v26 offset:8192
    ds_read_b64_tr_b16 v[214:215], v26 offset:12288
    ds_read_b64_tr_b16 v[216:217], v27 offset:8192
    ds_read_b64_tr_b16 v[218:219], v27 offset:12288
    s_add_u32 m0, s57, 12288
    s_waitcnt vmcnt(4)
    buffer_load_dwordx4 v12, s[24:27], s61 offen nt lds
    buffer_load_dwordx4 v13, s[24:27], s61 offen offset:1024 nt lds
    s_waitcnt lgkmcnt(6)
    v_mfma_f32_16x16x32_bf16 v[124:127], v[204:207], v[236:239], v[124:127]
    v_mfma_f32_16x16x32_bf16 v[156:159], v[204:207], v[240:243], v[156:159]
    s_waitcnt lgkmcnt(4)
    v_mfma_f32_16x16x32_bf16 v[128:131], v[208:211], v[236:239], v[128:131]
    v_mfma_f32_16x16x32_bf16 v[160:163], v[208:211], v[240:243], v[160:163]
    s_waitcnt vmcnt(4)
    buffer_load_dwordx4 v14, s[24:27], s61 offen offset:2048 nt lds
    buffer_load_dwordx4 v15, s[24:27], s61 offen offset:3072 nt lds
    s_waitcnt lgkmcnt(2)
    v_mfma_f32_16x16x32_bf16 v[132:135], v[212:215], v[236:239], v[132:135]
    v_mfma_f32_16x16x32_bf16 v[164:167], v[212:215], v[240:243], v[164:167]
    s_waitcnt lgkmcnt(0)
    v_mfma_f32_16x16x32_bf16 v[136:139], v[216:219], v[236:239], v[136:139]
    v_mfma_f32_16x16x32_bf16 v[168:171], v[216:219], v[240:243], v[168:171]
    v_xor_b32 v16, 0x4000, v16
    v_xor_b32 v17, 0x4000, v17
    v_xor_b32 v18, 0x4000, v18
    v_xor_b32 v19, 0x4000, v19
    v_xor_b32 v20, 0x4000, v20
    v_xor_b32 v21, 0x4000, v21
    v_xor_b32 v22, 0x4000, v22
    v_xor_b32 v23, 0x4000, v23
    v_xor_b32 v24, 0x4000, v24
    v_xor_b32 v25, 0x4000, v25
    v_xor_b32 v26, 0x4000, v26
    v_xor_b32 v27, 0x4000, v27
    s_xor_b32 s57, s57, 0x4000
    s_sub_u32 s59, s59, 1
    s_cmp_lg_u32 s59, 0
    s_cbranch_scc1 L_loopQ
    s_branch L_exit
.p2align 6
L_loopS:
    v_readlane_b32 s60, v8, s58
    v_readlane_b32 s61, v9, s58
    s_sub_u32 s63, s58, 1
    v_readlane_b32 s62, v10, s63
    s_add_u32 s58, s58, 1
    s_waitcnt vmcnt(4)
    ds_read_b128 v[172:175], v16
    ds_read_b128 v[176:179], v17
    ds_read_b128 v[180:183], v18
    ds_read_b128 v[184:187], v19
    ds_read_b128 v[188:191], v16 offset:4096
    ds_read_b128 v[192:195], v17 offset:4096
    ds_read_b128 v[196:199], v18 offset:4096
    ds_read_b128 v[200:203], v19 offset:4096
    s_mov_b32 m0, s57
    s_waitcnt vmcnt(4)
    buffer_load_dwordx4 v12, s[20:23], s60 offen nt lds
    buffer_load_dwordx4 v13, s[20:23], s60 offen offset:1024 nt lds
    s_waitcnt lgkmcnt(7)
    v_mfma_f32_16x16x32_bf16 v[220:223], v[172:175], v[44:47], 0
    v_mfma_f32_16x16x32_bf16 v[224:227], v[172:175], v[60:63], 0
    s_waitcnt lgkmcnt(6)
    v_mfma_f32_16x16x32_bf16 v[220:223], v[176:179], v[48:51], v[220:223]
    v_mfma_f32_16x16x32_bf16 v[224:227], v[176:179], v[64:67], v[224:227]
    s_waitcnt lgkmcnt(5)
    v_mfma_f32_16x16x32_bf16 v[220:223], v[180:183], v[52:55], v[220:223]
    v_mfma_f32_16x16x32_bf16 v[224:227], v[180:183], v[68:71], v[224:227]
    s_waitcnt lgkmcnt(4)
    v_mfma_f32_16x16x32_bf16 v[220:223], v[184:187], v[56:59], v[220:223]
    v_mfma_f32_16x16x32_bf16 v[224:227], v[184:187], v[72:75], v[224:227]
    s_waitcnt vmcnt(3)
    buffer_load_dwordx4 v14, s[20:23], s60 offen offset:2048 nt lds
    buffer_load_dwordx4 v15, s[20:23], s60 offen offset:3072 nt lds
    s_waitcnt lgkmcnt(3)
    v_mfma_f32_16x16x32_bf16 v[228:231], v[188:191], v[44:47], 0
    v_mfma_f32_16x16x32_bf16 v[232:235], v[188:191], v[60:63], 0
    s_waitcnt lgkmcnt(2)
    v_mfma_f32_16x16x32_bf16 v[228:231], v[192:195], v[48:51], v[228:231]
    v_mfma_f32_16x16x32_bf16 v[232:235], v[192:195], v[64:67], v[232:235]
    s_waitcnt lgkmcnt(1)
    v_mfma_f32_16x16x32_bf16 v[228:231], v[196:199], v[52:55], v[228:231]
    v_mfma_f32_16x16x32_bf16 v[232:235], v[196:199], v[68:71], v[232:235]
    s_waitcnt lgkmcnt(0)
    v_mfma_f32_16x16x32_bf16 v[228:231], v[200:203], v[56:59], v[228:231]
    v_mfma_f32_16x16x32_bf16 v[232:235], v[200:203], v[72:75], v[232:235]
    s_add_u32 m0, s57, 4096
    s_waitcnt vmcnt(4)
    buffer_load_dwordx4 v12, s[20:23], s61 offen nt lds
    buffer_load_dwordx4 v13, s[20:23], s61 offen offset:1024 nt lds
    s_nop 3
    s_cmp_eq_u32 s62, 0x1010
    s_cbranch_scc0 L_maskS
L_nomaskS:
    v_max3_f32 v33, v220, v221, v222
    v_max3_f32 v34, v224, v225, v226
    v_max3_f32 v33, v33, v223, v228
    v_max3_f32 v34, v34, v227, v232
    v_max3_f32 v33, v33, v229, v230
    v_max3_f32 v34, v34, v233, v234
    v_max_f32 v33, v33, v231
    v_max_f32 v34, v34, v235
    s_nop 1
    v_permlane32_swap_b32 v33, v34
    s_nop 0
    v_max_f32 v35, v33, v34
    v_max_f32 v36, v33, v34
    s_nop 1
    v_permlane16_swap_b32 v36, v35
    s_nop 0
    v_max_f32 v35, v36, v35
    v_mul_f32 v35, s55, v35
    v_max_f32 v31, v28, v35
    v_max_f32 v32, v28, v35
    v_cmp_gt_f32 vcc, v31, v28
    v_sub_f32 v37, v28, v31
    v_mov_b32 v28, v31
    v_permlane32_swap_b32 v31, v32
    s_cbranch_vccz L_norescaleS
    v_exp_f32 v38, v37
    v_exp_f32 v39, v37
    s_nop 1
    v_permlane32_swap_b32 v38, v39
    s_nop 0
    v_mul_f32 v29, v29, v38
    v_mul_f32 v30, v30, v39
    v_mul_f32 v108, v108, v38
    v_mul_f32 v109, v109, v38
    v_mul_f32 v110, v110, v38
    v_mul_f32 v111, v111, v38
    v_mul_f32 v112, v112, v38
    v_mul_f32 v113, v113, v38
    v_mul_f32 v114, v114, v38
    v_mul_f32 v115, v115, v38
    v_mul_f32 v116, v116, v38
    v_mul_f32 v117, v117, v38
    v_mul_f32 v118, v118, v38
    v_mul_f32 v119, v119, v38
    v_mul_f32 v120, v120, v38
    v_mul_f32 v121, v121, v38
    v_mul_f32 v122, v122, v38
    v_mul_f32 v123, v123, v38
    v_mul_f32 v124, v124, v38
    v_mul_f32 v125, v125, v38
    v_mul_f32 v126, v126, v38
    v_mul_f32 v127, v127, v38
    v_mul_f32 v128, v128, v38
    v_mul_f32 v129, v129, v38
    v_mul_f32 v130, v130, v38
    v_mul_f32 v131, v131, v38
    v_mul_f32 v132, v132, v38
    v_mul_f32 v133, v133, v38
    v_mul_f32 v134, v134, v38
    v_mul_f32 v135, v135, v38
    v_mul_f32 v136, v136, v38
    v_mul_f32 v137, v137, v38
    v_mul_f32 v138, v138, v38
    v_mul_f32 v139, v139, v38
    v_mul_f32 v140, v140, v39
    v_mul_f32 v141, v141, v39
    v_mul_f32 v142, v142, v39
    v_mul_f32 v143, v143, v39
    v_mul_f32 v144, v144, v39
    v_mul_f32 v145, v145, v39
    v_mul_f32 v146, v146, v39
    v_mul_f32 v147, v147, v39
    v_mul_f32 v148, v148, v39
    v_mul_f32 v149, v149, v39
    v_mul_f32 v150, v150, v39
    v_mul_f32 v151, v151, v39
    v_mul_f32 v152, v152, v39
    v_mul_f32 v153, v153, v39
    v_mul_f32 v154, v154, v39
    v_mul_f32 v155, v155, v39
    v_mul_f32 v156, v156, v39
    v_mul_f32 v157, v157, v39
    v_mul_f32 v158, v158, v39
    v_mul_f32 v159, v159, v39
    v_mul_f32 v160, v160, v39
    v_mul_f32 v161, v161, v39
    v_mul_f32 v162, v162, v39
    v_mul_f32 v163, v163, v39
    v_mul_f32 v164, v164, v39
    v_mul_f32 v165, v165, v39
    v_mul_f32 v166, v166, v39
    v_mul_f32 v167, v167, v39
    v_mul_f32 v168, v168, v39
    v_mul_f32 v169, v169, v39
    v_mul_f32 v170, v170, v39
    v_mul_f32 v171, v171, v39
L_norescaleS:
    s_waitcnt vmcnt(3)
    buffer_load_dwordx4 v14, s[20:23], s61 offen offset:2048 nt lds
    buffer_load_dwordx4 v15, s[20:23], s61 offen offset:3072 nt lds
    v_fma_f32 v220, v220, s55, -v31
    v_fma_f32 v221, v221, s55, -v31
    v_fma_f32 v222, v222, s55, -v31
    v_fma_f32 v223, v223, s55, -v31
    v_fma_f32 v224, v224, s55, -v32
    v_fma_f32 v225, v225, s55, -v32
    v_fma_f32 v226, v226, s55, -v32
    v_fma_f32 v227, v227, s55, -v32
    v_fma_f32 v228, v228, s55, -v31
    v_fma_f32 v229, v229, s55, -v31
    v_fma_f32 v230, v230, s55, -v31
    v_fma_f32 v231, v231, s55, -v31
    v_fma_f32 v232, v232, s55, -v32
    v_fma_f32 v233, v233, s55, -v32
    v_fma_f32 v234, v234, s55, -v32
    v_fma_f32 v235, v235, s55, -v32
    v_exp_f32 v220, v220
    v_exp_f32 v221, v221
    v_exp_f32 v222, v222
    v_exp_f32 v223, v223
    v_exp_f32 v224, v224
    v_exp_f32 v225, v225
    v_exp_f32 v226, v226
    v_exp_f32 v227, v227
    v_exp_f32 v228, v228
    v_exp_f32 v229, v229
    v_exp_f32 v230, v230
    v_exp_f32 v231, v231
    v_exp_f32 v232, v232
    v_exp_f32 v233, v233
    v_exp_f32 v234, v234
    v_exp_f32 v235, v235
    s_add_u32 m0, s57, 8192
    s_waitcnt vmcnt(4)
    buffer_load_dwordx4 v12, s[24:27], s60 offen nt lds
    buffer_load_dwordx4 v13, s[24:27], s60 offen offset:1024 nt lds
    ds_read_b64_tr_b16 v[204:205], v20 offset:8192
    ds_read_b64_tr_b16 v[206:207], v20 offset:12288
    ds_read_b64_tr_b16 v[208:209], v21 offset:8192
    ds_read_b64_tr_b16 v[210:211], v21 offset:12288
    ds_read_b64_tr_b16 v[212:213], v22 offset:8192
    ds_read_b64_tr_b16 v[214:215], v22 offset:12288
    ds_read_b64_tr_b16 v[216:217], v23 offset:8192
    ds_read_b64_tr_b16 v[218:219], v23 offset:12288
    v_cvt_pk_bf16_f32 v236, v220, v221
    v_cvt_pk_bf16_f32 v237, v222, v223
    v_cvt_pk_bf16_f32 v238, v228, v229
    v_cvt_pk_bf16_f32 v239, v230, v231
    v_cvt_pk_bf16_f32 v240, v224, v225
    v_cvt_pk_bf16_f32 v241, v226, v227
    v_cvt_pk_bf16_f32 v242, v232, v233
    v_cvt_pk_bf16_f32 v243, v234, v235
    v_add_f32 v220, v220, v221
    v_add_f32 v222, v222, v223
    v_add_f32 v228, v228, v229
    v_add_f32 v230, v230, v231
    v_add_f32 v220, v220, v222
    v_add_f32 v228, v228, v230
    v_add_f32 v29, v29, v220
    v_add_f32 v29, v29, v228
    v_add_f32 v224, v224, v225
    v_add_f32 v226, v226, v227
    v_add_f32 v232, v232, v233
    v_add_f32 v234, v234, v235
    v_add_f32 v224, v224, v226
    v_add_f32 v232, v232, v234
    v_add_f32 v30, v30, v224
    v_add_f32 v30, v30, v232
    s_waitcnt lgkmcnt(6)
    v_mfma_f32_16x16x32_bf16 v[108:111], v[204:207], v[236:239], v[108:111]
    v_mfma_f32_16x16x32_bf16 v[140:143], v[204:207], v[240:243], v[140:143]
    s_waitcnt lgkmcnt(4)
    v_mfma_f32_16x16x32_bf16 v[112:115], v[208:211], v[236:239], v[112:115]
    v_mfma_f32_16x16x32_bf16 v[144:147], v[208:211], v[240:243], v[144:147]
    ds_read_b64_tr_b16 v[204:205], v24 offset:8192
    ds_read_b64_tr_b16 v[206:207], v24 offset:12288
    ds_read_b64_tr_b16 v[208:209], v25 offset:8192
    ds_read_b64_tr_b16 v[210:211], v25 offset:12288
    s_waitcnt vmcnt(4)
    buffer_load_dwordx4 v14, s[24:27], s60 offen offset:2048 nt lds
    buffer_load_dwordx4 v15, s[24:27], s60 offen offset:3072 nt lds
    s_waitcnt lgkmcnt(6)
    v_mfma_f32_16x16x32_bf16 v[116:119], v[212:215], v[236:239], v[116:119]
    v_mfma_f32_16x16x32_bf16 v[148:151], v[212:215], v[240:243], v[148:151]
    s_waitcnt lgkmcnt(4)
    v_mfma_f32_16x16x32_bf16 v[120:123], v[216:219], v[236:239], v[120:123]
    v_mfma_f32_16x16x32_bf16 v[152:155], v[216:219], v[240:243], v[152:155]
    ds_read_b64_tr_b16 v[212:213], v26 offset:8192
    ds_read_b64_tr_b16 v[214:215], v26 offset:12288
    ds_read_b64_tr_b16 v[216:217], v27 offset:8192
    ds_read_b64_tr_b16 v[218:219], v27 offset:12288
    s_add_u32 m0, s57, 12288
    s_waitcnt vmcnt(4)
    buffer_load_dwordx4 v12, s[24:27], s61 offen nt lds
    buffer_load_dwordx4 v13, s[24:27], s61 offen offset:1024 nt lds
    s_waitcnt lgkmcnt(6)
    v_mfma_f32_16x16x32_bf16 v[124:127], v[204:207], v[236:239], v[124:127]
    v_mfma_f32_16x16x32_bf16 v[156:159], v[204:207], v[240:243], v[156:159]
    s_waitcnt lgkmcnt(4)
    v_mfma_f32_16x16x32_bf16 v[128:131], v[208:211], v[236:239], v[128:131]
    v_mfma_f32_16x16x32_bf16 v[160:163], v[208:211], v[240:243], v[160:163]
    s_waitcnt vmcnt(3)
    buffer_load_dwordx4 v14, s[24:27], s61 offen offset:2048 nt lds
    buffer_load_dwordx4 v15, s[24:27], s61 offen offset:3072 nt lds
    s_waitcnt lgkmcnt(2)
    v_mfma_f32_16x16x32_bf16 v[132:135], v[212:215], v[236:239], v[132:135]
    v_mfma_f32_16x16x32_bf16 v[164:167], v[212:215], v[240:243], v[164:167]
    s_waitcnt lgkmcnt(0)
    v_mfma_f32_16x16x32_bf16 v[136:139], v[216:219], v[236:239], v[136:139]
    v_mfma_f32_16x16x32_bf16 v[168:171], v[216:219], v[240:243], v[168:171]
    v_xor_b32 v16, 0x4000, v16
    v_xor_b32 v17, 0x4000, v17
    v_xor_b32 v18, 0x4000, v18
    v_xor_b32 v19, 0x4000, v19
    v_xor_b32 v20, 0x4000, v20
    v_xor_b32 v21, 0x4000, v21
    v_xor_b32 v22, 0x4000, v22
    v_xor_b32 v23, 0x4000, v23
    v_xor_b32 v24, 0x4000, v24
    v_xor_b32 v25, 0x4000, v25
    v_xor_b32 v26, 0x4000, v26
    v_xor_b32 v27, 0x4000, v27
    s_xor_b32 s57, s57, 0x4000
    s_sub_u32 s59, s59, 1
    s_cmp_lg_u32 s59, 0
    s_cbranch_scc1 L_loopS
    s_branch L_exit
.p2align 6
L_loopB:
    v_readlane_b32 s60, v8, s58
    v_readlane_b32 s61, v9, s58
    s_sub_u32 s63, s58, 1
    v_readlane_b32 s62, v10, s63
    s_add_u32 s58, s58, 1
    s_waitcnt vmcnt(6)
    ds_read_b128 v[172:175], v16
    ds_read_b128 v[176:179], v17
    ds_read_b128 v[180:183], v18
    ds_read_b128 v[184:187], v19
    ds_read_b128 v[188:191], v16 offset:4096
    ds_read_b128 v[192:195], v17 offset:4096
    ds_read_b128 v[196:199], v18 offset:4096
    ds_read_b128 v[200:203], v19 offset:4096
    s_mov_b32 m0, s57
    s_waitcnt vmcnt(6)
    buffer_load_dwordx4 v12, s[20:23], s60 offen nt lds
    buffer_load_dwordx4 v13, s[20:23], s60 offen offset:1024 nt lds
    s_waitcnt lgkmcnt(7)
    v_mfma_f32_16x16x32_bf16 v[220:223], v[172:175], v[44:47], 0
    v_mfma_f32_16x16x32_bf16 v[224:227], v[172:175], v[60:63], 0
    s_waitcnt lgkmcnt(6)
    v_mfma_f32_16x16x32_bf16 v[220:223], v[176:179], v[48:51], v[220:223]
    v_mfma_f32_16x16x32_bf16 v[224:227], v[176:179], v[64:67], v[224:227]
    s_waitcnt lgkmcnt(5)
    v_mfma_f32_16x16x32_bf16 v[220:223], v[180:183], v[52:55], v[220:223]
    v_mfma_f32_16x16x32_bf16 v[224:227], v[180:183], v[68:71], v[224:227]
    s_waitcnt lgkmcnt(4)
    v_mfma_f32_16x16x32_bf16 v[220:223], v[184:187], v[56:59], v[220:223]
    v_mfma_f32_16x16x32_bf16 v[224:227], v[184:187], v[72:75], v[224:227]
    s_waitcnt vmcnt(6)
    buffer_load_dwordx4 v14, s[20:23], s60 offen offset:2048 nt lds
    buffer_load_dwordx4 v15, s[20:23], s60 offen offset:3072 nt lds
    s_waitcnt lgkmcnt(3)
    v_mfma_f32_16x16x32_bf16 v[228:231], v[188:191], v[44:47], 0
    v_mfma_f32_16x16x32_bf16 v[232:235], v[188:191], v[60:63], 0
    s_waitcnt lgkmcnt(2)
    v_mfma_f32_16x16x32_bf16 v[228:231], v[192:195], v[48:51], v[228:231]
    v_mfma_f32_16x16x32_bf16 v[232:235], v[192:195], v[64:67], v[232:235]
    s_waitcnt lgkmcnt(1)
    v_mfma_f32_16x16x32_bf16 v[228:231], v[196:199], v[52:55], v[228:231]
    v_mfma_f32_16x16x32_bf16 v[232:235], v[196:199], v[68:71], v[232:235]
    s_waitcnt lgkmcnt(0)
    v_mfma_f32_16x16x32_bf16 v[228:231], v[200:203], v[56:59], v[228:231]
    v_mfma_f32_16x16x32_bf16 v[232:235], v[200:203], v[72:75], v[232:235]
    s_add_u32 m0, s57, 4096
    s_waitcnt vmcnt(6)
    buffer_load_dwordx4 v12, s[20:23], s61 offen nt lds
    buffer_load_dwordx4 v13, s[20:23], s61 offen offset:1024 nt lds
    s_nop 3
    s_cmp_eq_u32 s62, 0x1010
    s_cbranch_scc0 L_maskB
L_nomaskB:
    v_max3_f32 v33, v220, v221, v222
    v_max3_f32 v34, v224, v225, v226
    v_max3_f32 v33, v33, v223, v228
    v_max3_f32 v34, v34, v227, v232
    v_max3_f32 v33, v33, v229, v230
    v_max3_f32 v34, v34, v233, v234
    v_max_f32 v33, v33, v231
    v_max_f32 v34, v34, v235
    s_nop 1
    v_permlane32_swap_b32 v33, v34
    s_nop 0
    v_max_f32 v35, v33, v34
    v_max_f32 v36, v33, v34
    s_nop 1
    v_permlane16_swap_b32 v36, v35
    s_nop 0
    v_max_f32 v35, v36, v35
    v_mul_f32 v35, s55, v35
    v_max_f32 v31, v28, v35
    v_max_f32 v32, v28, v35
    v_cmp_gt_f32 vcc, v31, v28
    v_sub_f32 v37, v28, v31
    v_mov_b32 v28, v31
    v_permlane32_swap_b32 v31, v32
    s_cbranch_vccz L_norescaleB
    v_exp_f32 v38, v37
    v_exp_f32 v39, v37
    s_nop 1
    v_permlane32_swap_b32 v38, v39
    s_nop 0
    v_mul_f32 v29, v29, v38
    v_mul_f32 v30, v30, v39
    v_mul_f32 v108, v108, v38
    v_mul_f32 v109, v109, v38
    v_mul_f32 v110, v110, v38
    v_mul_f32 v111, v111, v38
    v_mul_f32 v112, v112, v38
    v_mul_f32 v113, v113, v38
    v_mul_f32 v114, v114, v38
    v_mul_f32 v115, v115, v38
    v_mul_f32 v116, v116, v38
    v_mul_f32 v117, v117, v38
    v_mul_f32 v118, v118, v38
    v_mul_f32 v119, v119, v38
    v_mul_f32 v120, v120, v38
    v_mul_f32 v121, v121, v38
    v_mul_f32 v122, v122, v38
    v_mul_f32 v123, v123, v38
    v_mul_f32 v124, v124, v38
    v_mul_f32 v125, v125, v38
    v_mul_f32 v126, v126, v38
    v_mul_f32 v127, v127, v38
    v_mul_f32 v128, v128, v38
    v_mul_f32 v129, v129, v38
    v_mul_f32 v130, v130, v38
    v_mul_f32 v131, v131, v38
    v_mul_f32 v132, v132, v38
    v_mul_f32 v133, v133, v38
    v_mul_f32 v134, v134, v38
    v_mul_f32 v135, v135, v38
    v_mul_f32 v136, v136, v38
    v_mul_f32 v137, v137, v38
    v_mul_f32 v138, v138, v38
    v_mul_f32 v139, v139, v38
    v_mul_f32 v140, v140, v39
    v_mul_f32 v141, v141, v39
    v_mul_f32 v142, v142, v39
    v_mul_f32 v143, v143, v39
    v_mul_f32 v144, v144, v39
    v_mul_f32 v145, v145, v39
    v_mul_f32 v146, v146, v39
    v_mul_f32 v147, v147, v39
    v_mul_f32 v148, v148, v39
    v_mul_f32 v149, v149, v39
    v_mul_f32 v150, v150, v39
    v_mul_f32 v151, v151, v39
    v_mul_f32 v152, v152, v39
    v_mul_f32 v153, v153, v39
    v_mul_f32 v154, v154, v39
    v_mul_f32 v155, v155, v39
    v_mul_f32 v156, v156, v39
    v_mul_f32 v157, v157, v39
    v_mul_f32 v158, v158, v39
    v_mul_f32 v159, v159, v39
    v_mul_f32 v160, v160, v39
    v_mul_f32 v161, v161, v39
    v_mul_f32 v162, v162, v39
    v_mul_f32 v163, v163, v39
    v_mul_f32 v164, v164, v39
    v_mul_f32 v165, v165, v39
    v_mul_f32 v166, v166, v39
    v_mul_f32 v167, v167, v39
    v_mul_f32 v168, v168, v39
    v_mul_f32 v169, v169, v39
    v_mul_f32 v170, v170, v39
    v_mul_f32 v171, v171, v39
L_norescaleB:
    s_waitcnt vmcnt(6)
    buffer_load_dwordx4 v14, s[20:23], s61 offen offset:2048 nt lds
    buffer_load_dwordx4 v15, s[20:23], s61 offen offset:3072 nt lds
    v_fma_f32 v220, v220, s55, -v31
    v_fma_f32 v221, v221, s55, -v31
    v_fma_f32 v222, v222, s55, -v31
    v_fma_f32 v223, v223, s55, -v31
    v_fma_f32 v224, v224, s55, -v32
    v_fma_f32 v225, v225, s55, -v32
    v_fma_f32 v226, v226, s55, -v32
    v_fma_f32 v227, v227, s55, -v32
    v_fma_f32 v228, v228, s55, -v31
    v_fma_f32 v229, v229, s55, -v31
    v_fma_f32 v230, v230, s55, -v31
    v_fma_f32 v231, v231, s55, -v31
    v_fma_f32 v232, v232, s55, -v32
    v_fma_f32 v233, v233, s55, -v32
    v_fma_f32 v234, v234, s55, -v32
    v_fma_f32 v235, v235, s55, -v32
    v_exp_f32 v220, v220
    v_exp_f32 v221, v221
    v_exp_f32 v222, v222
    v_exp_f32 v223, v223
    v_exp_f32 v224, v224
    v_exp_f32 v225, v225
    v_exp_f32 v226, v226
    v_exp_f32 v227, v227
    v_exp_f32 v228, v228
    v_exp_f32 v229, v229
    v_exp_f32 v230, v230
    v_exp_f32 v231, v231
    v_exp_f32 v232, v232
    v_exp_f32 v233, v233
    v_exp_f32 v234, v234
    v_exp_f32 v235, v235
    s_add_u32 m0, s57, 8192
    s_waitcnt vmcnt(6)
    buffer_load_dwordx4 v12, s[24:27], s60 offen nt lds
    buffer_load_dwordx4 v13, s[24:27], s60 offen offset:1024 nt lds
    ds_read_b64_tr_b16 v[204:205], v20 offset:8192
    ds_read_b64_tr_b16 v[206:207], v20 offset:12288
    ds_read_b64_tr_b16 v[208:209], v21 offset:8192
    ds_read_b64_tr_b16 v[210:211], v21 offset:12288
    ds_read_b64_tr_b16 v[212:213], v22 offset:8192
    ds_read_b64_tr_b16 v[214:215], v22 offset:12288
    ds_read_b64_tr_b16 v[216:217], v23 offset:8192
    ds_read_b64_tr_b16 v[218:219], v23 offset:12288
    v_cvt_pk_bf16_f32 v236, v220, v221
    v_cvt_pk_bf16_f32 v237, v222, v223
    v_cvt_pk_bf16_f32 v238, v228, v229
    v_cvt_pk_bf16_f32 v239, v230, v231
    v_cvt_pk_bf16_f32 v240, v224, v225
    v_cvt_pk_bf16_f32 v241, v226, v227
    v_cvt_pk_bf16_f32 v242, v232, v233
    v_cvt_pk_bf16_f32 v243, v234, v235
    v_add_f32 v220, v220, v221
    v_add_f32 v222, v222, v223
    v_add_f32 v228, v228, v229
    v_add_f32 v230, v230, v231
    v_add_f32 v220, v220, v222
    v_add_f32 v228, v228, v230
    v_add_f32 v29, v29, v220
    v_add_f32 v29, v29, v228
    v_add_f32 v224, v224, v225
    v_add_f32 v226, v226, v227
    v_add_f32 v232, v232, v233
    v_add_f32 v234, v234, v235
    v_add_f32 v224, v224, v226
    v_add_f32 v232, v232, v234
    v_add_f32 v30, v30, v224
    v_add_f32 v30, v30, v232
    s_waitcnt lgkmcnt(6)
    v_mfma_f32_16x16x32_bf16 v[108:111], v[204:207], v[236:239], v[108:111]
    v_mfma_f32_16x16x32_bf16 v[140:143], v[204:207], v[240:243], v[140:143]
    s_waitcnt lgkmcnt(4)
    v_mfma_f32_16x16x32_bf16 v[112:115], v[208:211], v[236:239], v[112:115]
    v_mfma_f32_16x16x32_bf16 v[144:147], v[208:211], v[240:243], v[144:147]
    ds_read_b64_tr_b16 v[204:205], v24 offset:8192
    ds_read_b64_tr_b16 v[206:207], v24 offset:12288
    ds_read_b64_tr_b16 v[208:209], v25 offset:8192
    ds_read_b64_tr_b16 v[210:211], v25 offset:12288
    s_waitcnt vmcnt(6)
    buffer_load_dwordx4 v14, s[24:27], s60 offen offset:2048 nt lds
    buffer_load_dwordx4 v15, s[24:27], s60 offen offset:3072 nt lds
    s_waitcnt lgkmcnt(6)
    v_mfma_f32_16x16x32_bf16 v[116:119], v[212:215], v[236:239], v[116:119]
    v_mfma_f32_16x16x32_bf16 v[148:151], v[212:215], v[240:243], v[148:151]
    s_waitcnt lgkmcnt(4)
    v_mfma_f32_16x16x32_bf16 v[120:123], v[216:219], v[236:239], v[120:123]
    v_mfma_f32_16x16x32_bf16 v[152:155], v[216:219], v[240:243], v[152:155]
    ds_read_b64_tr_b16 v[212:213], v26 offset:8192
    ds_read_b64_tr_b16 v[214:215], v26 offset:12288
    ds_read_b64_tr_b16 v[216:217], v27 offset:8192
    ds_read_b64_tr_b16 v[218:219], v27 offset:12288
    s_add_u32 m0, s57, 12288
    s_waitcnt vmcnt(6)
    buffer_load_dwordx4 v12, s[24:27], s61 offen nt lds
    buffer_load_dwordx4 v13, s[24:27], s61 offen offset:1024 nt lds
    s_waitcnt lgkmcnt(6)
    v_mfma_f32_16x16x32_bf16 v[124:127], v[204:207], v[236:239], v[124:127]
    v_mfma_f32_16x16x32_bf16 v[156:159], v[204:207], v[240:243], v[156:159]
    s_waitcnt lgkmcnt(4)
    v_mfma_f32_16x16x32_bf16 v[128:131], v[208:211], v[236:239], v[128:131]
    v_mfma_f32_16x16x32_bf16 v[160:163], v[208:211], v[240:243], v[160:163]
    s_waitcnt vmcnt(6)
    buffer_load_dwordx4 v14, s[24:27], s61 offen offset:2048 nt lds
    buffer_load_dwordx4 v15, s[24:27], s61 offen offset:3072 nt lds
    s_waitcnt lgkmcnt(2)
    v_mfma_f32_16x16x32_bf16 v[132:135], v[212:215], v[236:239], v[132:135]
    v_mfma_f32_16x16x32_bf16 v[164:167], v[212:215], v[240:243], v[164:167]
    s_waitcnt lgkmcnt(0)
    v_mfma_f32_16x16x32_bf16 v[136:139], v[216:219], v[236:239], v[136:139]
    v_mfma_f32_16x16x32_bf16 v[168:171], v[216:219], v[240:243], v[168:171]
    v_xor_b32 v16, 0x4000, v16
    v_xor_b32 v17, 0x4000, v17
    v_xor_b32 v18, 0x4000, v18
    v_xor_b32 v19, 0x4000, v19
    v_xor_b32 v20, 0x4000, v20
    v_xor_b32 v21, 0x4000, v21
    v_xor_b32 v22, 0x4000, v22
    v_xor_b32 v23, 0x4000, v23
    v_xor_b32 v24, 0x4000, v24
    v_xor_b32 v25, 0x4000, v25
    v_xor_b32 v26, 0x4000, v26
    v_xor_b32 v27, 0x4000, v27
    s_xor_b32 s57, s57, 0x4000
    s_sub_u32 s59, s59, 1
    s_cmp_lg_u32 s59, 0
    s_cbranch_scc1 L_loopB
    s_branch L_exit
.p2align 6
L_loopP:
    v_readlane_b32 s60, v8, s58
    v_readlane_b32 s61, v9, s58
    s_sub_u32 s63, s58, 1
    v_readlane_b32 s62, v10, s63
    s_add_u32 s58, s58, 1
    s_waitcnt vmcnt(9)
    ds_read_b128 v[172:175], v16
    ds_read_b128 v[176:179], v17
    ds_read_b128 v[180:183], v18
    ds_read_b128 v[184:187], v19
    ds_read_b128 v[188:191], v16 offset:4096
    ds_read_b128 v[192:195], v17 offset:4096
    ds_read_b128 v[196:199], v18 offset:4096
    ds_read_b128 v[200:203], v19 offset:4096
    s_mov_b32 m0, s57
    s_waitcnt vmcnt(9)
    buffer_load_dwordx4 v12, s[20:23], s60 offen nt lds
    buffer_load_dwordx4 v13, s[20:23], s60 offen offset:1024 nt lds
    s_waitcnt lgkmcnt(7)
    v_mfma_f32_16x16x32_bf16 v[220:223], v[172:175], v[44:47], 0
    v_mfma_f32_16x16x32_bf16 v[224:227], v[172:175], v[60:63], 0
    s_waitcnt lgkmcnt(6)
    v_mfma_f32_16x16x32_bf16 v[220:223], v[176:179], v[48:51], v[220:223]
    v_mfma_f32_16x16x32_bf16 v[224:227], v[176:179], v[64:67], v[224:227]
    s_waitcnt lgkmcnt(5)
    v_mfma_f32_16x16x32_bf16 v[220:223], v[180:183], v[52:55], v[220:223]
    v_mfma_f32_16x16x32_bf16 v[224:227], v[180:183], v[68:71], v[224:227]
    s_waitcnt lgkmcnt(4)
    v_mfma_f32_16x16x32_bf16 v[220:223], v[184:187], v[56:59], v[220:223]
    v_mfma_f32_16x16x32_bf16 v[224:227], v[184:187], v[72:75], v[224:227]
    s_waitcnt vmcnt(9)
    buffer_load_dwordx4 v14, s[20:23], s60 offen offset:2048 nt lds
    buffer_load_dwordx4 v15, s[20:23], s60 offen offset:3072 nt lds
    s_waitcnt lgkmcnt(3)
    v_mfma_f32_16x16x32_bf16 v[228:231], v[188:191], v[44:47], 0
    v_mfma_f32_16x16x32_bf16 v[232:235], v[188:191], v[60:63], 0
    s_waitcnt lgkmcnt(2)
    v_mfma_f32_16x16x32_bf16 v[228:231], v[192:195], v[48:51], v[228:231]
    v_mfma_f32_16x16x32_bf16 v[232:235], v[192:195], v[64:67], v[232:235]
    s_waitcnt lgkmcnt(1)
    v_mfma_f32_16x16x32_bf16 v[228:231], v[196:199], v[52:55], v[228:231]
    v_mfma_f32_16x16x32_bf16 v[232:235], v[196:199], v[68:71], v[232:235]
    s_waitcnt lgkmcnt(0)
    v_mfma_f32_16x16x32_bf16 v[228:231], v[200:203], v[56:59], v[228:231]
    v_mfma_f32_16x16x32_bf16 v[232:235], v[200:203], v[72:75], v[232:235]
    s_add_u32 m0, s57, 4096
    s_waitcnt vmcnt(9)
    buffer_load_dwordx4 v12, s[20:23], s61 offen nt lds
    buffer_load_dwordx4 v13, s[20:23], s61 offen offset:1024 nt lds
    s_nop 3
    s_cmp_eq_u32 s62, 0x1010
    s_cbranch_scc0 L_maskP
L_nomaskP:
    v_max3_f32 v33, v220, v221, v222
    v_max3_f32 v34, v224, v225, v226
    v_max3_f32 v33, v33, v223, v228
    v_max3_f32 v34, v34, v227, v232
    v_max3_f32 v33, v33, v229, v230
    v_max3_f32 v34, v34, v233, v234
    v_max_f32 v33, v33, v231
    v_max_f32 v34, v34, v235
    s_nop 1
    v_permlane32_swap_b32 v33, v34
    s_nop 0
    v_max_f32 v35, v33, v34
    v_max_f32 v36, v33, v34
    s_nop 1
    v_permlane16_swap_b32 v36, v35
    s_nop 0
    v_max_f32 v35, v36, v35
    v_mul_f32 v35, s55, v35
    v_max_f32 v31, v28, v35
    v_max_f32 v32, v28, v35
    v_cmp_gt_f32 vcc, v31, v28
    v_sub_f32 v37, v28, v31
    v_mov_b32 v28, v31
    v_permlane32_swap_b32 v31, v32
    s_cbranch_vccz L_norescaleP
    v_exp_f32 v38, v37
    v_exp_f32 v39, v37
    s_nop 1
    v_permlane32_swap_b32 v38, v39
    s_nop 0
    v_mul_f32 v29, v29, v38
    v_mul_f32 v30, v30, v39
    v_mul_f32 v108, v108, v38
    v_mul_f32 v109, v109, v38
    v_mul_f32 v110, v110, v38
    v_mul_f32 v111, v111, v38
    v_mul_f32 v112, v112, v38
    v_mul_f32 v113, v113, v38
    v_mul_f32 v114, v114, v38
    v_mul_f32 v115, v115, v38
    v_mul_f32 v116, v116, v38
    v_mul_f32 v117, v117, v38
    v_mul_f32 v118, v118, v38
    v_mul_f32 v119, v119, v38
    v_mul_f32 v120, v120, v38
    v_mul_f32 v121, v121, v38
    v_mul_f32 v122, v122, v38
    v_mul_f32 v123, v123, v38
    v_mul_f32 v124, v124, v38
    v_mul_f32 v125, v125, v38
    v_mul_f32 v126, v126, v38
    v_mul_f32 v127, v127, v38
    v_mul_f32 v128, v128, v38
    v_mul_f32 v129, v129, v38
    v_mul_f32 v130, v130, v38
    v_mul_f32 v131, v131, v38
    v_mul_f32 v132, v132, v38
    v_mul_f32 v133, v133, v38
    v_mul_f32 v134, v134, v38
    v_mul_f32 v135, v135, v38
    v_mul_f32 v136, v136, v38
    v_mul_f32 v137, v137, v38
    v_mul_f32 v138, v138, v38
    v_mul_f32 v139, v139, v38
    v_mul_f32 v140, v140, v39
    v_mul_f32 v141, v141, v39
    v_mul_f32 v142, v142, v39
    v_mul_f32 v143, v143, v39
    v_mul_f32 v144, v144, v39
    v_mul_f32 v145, v145, v39
    v_mul_f32 v146, v146, v39
    v_mul_f32 v147, v147, v39
    v_mul_f32 v148, v148, v39
    v_mul_f32 v149, v149, v39
    v_mul_f32 v150, v150, v39
    v_mul_f32 v151, v151, v39
    v_mul_f32 v152, v152, v39
    v_mul_f32 v153, v153, v39
    v_mul_f32 v154, v154, v39
    v_mul_f32 v155, v155, v39
    v_mul_f32 v156, v156, v39
    v_mul_f32 v157, v157, v39
    v_mul_f32 v158, v158, v39
    v_mul_f32 v159, v159, v39
    v_mul_f32 v160, v160, v39
    v_mul_f32 v161, v161, v39
    v_mul_f32 v162, v162, v39
    v_mul_f32 v163, v163, v39
    v_mul_f32 v164, v164, v39
    v_mul_f32 v165, v165, v39
    v_mul_f32 v166, v166, v39
    v_mul_f32 v167, v167, v39
    v_mul_f32 v168, v168, v39
    v_mul_f32 v169, v169, v39
    v_mul_f32 v170, v170, v39
    v_mul_f32 v171, v171, v39
L_norescaleP:
    s_waitcnt vmcnt(8)
    buffer_load_dwordx4 v14, s[20:23], s61 offen offset:2048 nt lds
    buffer_load_dwordx4 v15, s[20:23], s61 offen offset:3072 nt lds
    v_fma_f32 v220, v220, s55, -v31
    v_fma_f32 v221, v221, s55, -v31
    v_fma_f32 v222, v222, s55, -v31
    v_fma_f32 v223, v223, s55, -v31
    v_fma_f32 v224, v224, s55, -v32
    v_fma_f32 v225, v225, s55, -v32
    v_fma_f32 v226, v226, s55, -v32
    v_fma_f32 v227, v227, s55, -v32
    v_fma_f32 v228, v228, s55, -v31
    v_fma_f32 v229, v229, s55, -v31
    v_fma_f32 v230, v230, s55, -v31
    v_fma_f32 v231, v231, s55, -v31
    v_fma_f32 v232, v232, s55, -v32
    v_fma_f32 v233, v233, s55, -v32
    v_fma_f32 v234, v234, s55, -v32
    v_fma_f32 v235, v235, s55, -v32
    v_exp_f32 v220, v220
    v_exp_f32 v221, v221
    v_exp_f32 v222, v222
    v_exp_f32 v223, v223
    v_exp_f32 v224, v224
    v_exp_f32 v225, v225
    v_exp_f32 v226, v226
    v_exp_f32 v227, v227
    v_exp_f32 v228, v228
    v_exp_f32 v229, v229
    v_exp_f32 v230, v230
    v_exp_f32 v231, v231
    v_exp_f32 v232, v232
    v_exp_f32 v233, v233
    v_exp_f32 v234, v234
    v_exp_f32 v235, v235
    s_add_u32 m0, s57, 8192
    s_waitcnt vmcnt(9)
    buffer_load_dwordx4 v12, s[24:27], s60 offen nt lds
    buffer_load_dwordx4 v13, s[24:27], s60 offen offset:1024 nt lds
    ds_read_b64_tr_b16 v[204:205], v20 offset:8192
    ds_read_b64_tr_b16 v[206:207], v20 offset:12288
    ds_read_b64_tr_b16 v[208:209], v21 offset:8192
    ds_read_b64_tr_b16 v[210:211], v21 offset:12288
    ds_read_b64_tr_b16 v[212:213], v22 offset:8192
    ds_read_b64_tr_b16 v[214:215], v22 offset:12288
    ds_read_b64_tr_b16 v[216:217], v23 offset:8192
    ds_read_b64_tr_b16 v[218:219], v23 offset:12288
    v_cvt_pk_bf16_f32 v236, v220, v221
    v_cvt_pk_bf16_f32 v237, v222, v223
    v_cvt_pk_bf16_f32 v238, v228, v229
    v_cvt_pk_bf16_f32 v239, v230, v231
    v_cvt_pk_bf16_f32 v240, v224, v225
    v_cvt_pk_bf16_f32 v241, v226, v227
    v_cvt_pk_bf16_f32 v242, v232, v233
    v_cvt_pk_bf16_f32 v243, v234, v235
    v_add_f32 v220, v220, v221
    v_add_f32 v222, v222, v223
    v_add_f32 v228, v228, v229
    v_add_f32 v230, v230, v231
    v_add_f32 v220, v220, v222
    v_add_f32 v228, v228, v230
    v_add_f32 v29, v29, v220
    v_add_f32 v29, v29, v228
    v_add_f32 v224, v224, v225
    v_add_f32 v226, v226, v227
    v_add_f32 v232, v232, v233
    v_add_f32 v234, v234, v235
    v_add_f32 v224, v224, v226
    v_add_f32 v232, v232, v234
    v_add_f32 v30, v30, v224
    v_add_f32 v30, v30, v232
    s_waitcnt lgkmcnt(6)
    v_mfma_f32_16x16x32_bf16 v[108:111], v[204:207], v[236:239], v[108:111]
    v_mfma_f32_16x16x32_bf16 v[140:143], v[204:207], v[240:243], v[140:143]
    s_waitcnt lgkmcnt(4)
    v_mfma_f32_16x16x32_bf16 v[112:115], v[208:211], v[236:239], v[112:115]
    v_mfma_f32_16x16x32_bf16 v[144:147], v[208:211], v[240:243], v[144:147]
    ds_read_b64_tr_b16 v[204:205], v24 offset:8192
    ds_read_b64_tr_b16 v[206:207], v24 offset:12288
    ds_read_b64_tr_b16 v[208:209], v25 offset:8192
    ds_read_b64_tr_b16 v[210:211], v25 offset:12288
    s_waitcnt vmcnt(9)
    buffer_load_dwordx4 v14, s[24:27], s60 offen offset:2048 nt lds
    buffer_load_dwordx4 v15, s[24:27], s60 offen offset:3072 nt lds
    s_waitcnt lgkmcnt(6)
    v_mfma_f32_16x16x32_bf16 v[116:119], v[212:215], v[236:239], v[116:119]
    v_mfma_f32_16x16x32_bf16 v[148:151], v[212:215], v[240:243], v[148:151]
    s_waitcnt lgkmcnt(4)
    v_mfma_f32_16x16x32_bf16 v[120:123], v[216:219], v[236:239], v[120:123]
    v_mfma_f32_16x16x32_bf16 v[152:155], v[216:219], v[240:243], v[152:155]
    ds_read_b64_tr_b16 v[212:213], v26 offset:8192
    ds_read_b64_tr_b16 v[214:215], v26 offset:12288
    ds_read_b64_tr_b16 v[216:217], v27 offset:8192
    ds_read_b64_tr_b16 v[218:219], v27 offset:12288
    s_add_u32 m0, s57, 12288
    s_waitcnt vmcnt(9)
    buffer_load_dwordx4 v12, s[24:27], s61 offen nt lds
    buffer_load_dwordx4 v13, s[24:27], s61 offen offset:1024 nt lds
    s_waitcnt lgkmcnt(6)
    v_mfma_f32_16x16x32_bf16 v[124:127], v[204:207], v[236:239], v[124:127]
    v_mfma_f32_16x16x32_bf16 v[156:159], v[204:207], v[240:243], v[156:159]
    s_waitcnt lgkmcnt(4)
    v_mfma_f32_16x16x32_bf16 v[128:131], v[208:211], v[236:239], v[128:131]
    v_mfma_f32_16x16x32_bf16 v[160:163], v[208:211], v[240:243], v[160:163]
    s_waitcnt vmcnt(9)
    buffer_load_dwordx4 v14, s[24:27], s61 offen offset:2048 nt lds
    buffer_load_dwordx4 v15, s[24:27], s61 offen offset:3072 nt lds
    s_waitcnt lgkmcnt(2)
    v_mfma_f32_16x16x32_bf16 v[132:135], v[212:215], v[236:239], v[132:135]
    v_mfma_f32_16x16x32_bf16 v[164:167], v[212:215], v[240:243], v[164:167]
    s_waitcnt lgkmcnt(0)
    v_mfma_f32_16x16x32_bf16 v[136:139], v[216:219], v[236:239], v[136:139]
    v_mfma_f32_16x16x32_bf16 v[168:171], v[216:219], v[240:243], v[168:171]
    v_xor_b32 v16, 0x4000, v16
    v_xor_b32 v17, 0x4000, v17
    v_xor_b32 v18, 0x4000, v18
    v_xor_b32 v19, 0x4000, v19
    v_xor_b32 v20, 0x4000, v20
    v_xor_b32 v21, 0x4000, v21
    v_xor_b32 v22, 0x4000, v22
    v_xor_b32 v23, 0x4000, v23
    v_xor_b32 v24, 0x4000, v24
    v_xor_b32 v25, 0x4000, v25
    v_xor_b32 v26, 0x4000, v26
    v_xor_b32 v27, 0x4000, v27
    s_xor_b32 s57, s57, 0x4000
    s_sub_u32 s59, s59, 1
    s_cmp_lg_u32 s59, 0
    s_cbranch_scc1 L_loopP
    s_branch L_exit
.p2align 6
L_loopD:
    v_readlane_b32 s60, v8, s58
    v_readlane_b32 s61, v9, s58
    s_sub_u32 s63, s58, 1
    v_readlane_b32 s62, v10, s63
    s_add_u32 s58, s58, 1
    s_waitcnt vmcnt(8)
    ds_read_b128 v[172:175], v16
    ds_read_b128 v[176:179], v17
    ds_read_b128 v[180:183], v18
    ds_read_b128 v[184:187], v19
    ds_read_b128 v[188:191], v16 offset:4096
    ds_read_b128 v[192:195], v17 offset:4096
    ds_read_b128 v[196:199], v18 offset:4096
    ds_read_b128 v[200:203], v19 offset:4096
    s_mov_b32 m0, s57
    s_waitcnt vmcnt(12)
    buffer_load_dwordx4 v12, s[20:23], s60 offen nt lds
    buffer_load_dwordx4 v13, s[20:23], s60 offen offset:1024 nt lds
    s_waitcnt lgkmcnt(7)
    v_mfma_f32_16x16x32_bf16 v[220:223], v[172:175], v[44:47], 0
    v_mfma_f32_16x16x32_bf16 v[224:227], v[172:175], v[60:63], 0
    s_waitcnt lgkmcnt(6)
    v_mfma_f32_16x16x32_bf16 v[220:223], v[176:179], v[48:51], v[220:223]
    v_mfma_f32_16x16x32_bf16 v[224:227], v[176:179], v[64:67], v[224:227]
    s_waitcnt lgkmcnt(5)
    v_mfma_f32_16x16x32_bf16 v[220:223], v[180:183], v[52:55], v[220:223]
    v_mfma_f32_16x16x32_bf16 v[224:227], v[180:183], v[68:71], v[224:227]
    s_waitcnt lgkmcnt(4)
    v_mfma_f32_16x16x32_bf16 v[220:223], v[184:187], v[56:59], v[220:223]
    v_mfma_f32_16x16x32_bf16 v[224:227], v[184:187], v[72:75], v[224:227]
    s_waitcnt vmcnt(12)
    buffer_load_dwordx4 v14, s[20:23], s60 offen offset:2048 nt lds
    buffer_load_dwordx4 v15, s[20:23], s60 offen offset:3072 nt lds
    s_waitcnt lgkmcnt(3)
    v_mfma_f32_16x16x32_bf16 v[228:231], v[188:191], v[44:47], 0
    v_mfma_f32_16x16x32_bf16 v[232:235], v[188:191], v[60:63], 0
    s_waitcnt lgkmcnt(2)
    v_mfma_f32_16x16x32_bf16 v[228:231], v[192:195], v[48:51], v[228:231]
    v_mfma_f32_16x16x32_bf16 v[232:235], v[192:195], v[64:67], v[232:235]
    s_waitcnt lgkmcnt(1)
    v_mfma_f32_16x16x32_bf16 v[228:231], v[196:199], v[52:55], v[228:231]
    v_mfma_f32_16x16x32_bf16 v[232:235], v[196:199], v[68:71], v[232:235]
    s_waitcnt lgkmcnt(0)
    v_mfma_f32_16x16x32_bf16 v[228:231], v[200:203], v[56:59], v[228:231]
    v_mfma_f32_16x16x32_bf16 v[232:235], v[200:203], v[72:75], v[232:235]
    s_add_u32 m0, s57, 4096
    s_waitcnt vmcnt(12)
    buffer_load_dwordx4 v12, s[20:23], s61 offen nt lds
    buffer_load_dwordx4 v13, s[20:23], s61 offen offset:1024 nt lds
    s_nop 3
    s_cmp_eq_u32 s62, 0x1010
    s_cbranch_scc0 L_maskD
L_nomaskD:
    v_max3_f32 v33, v220, v221, v222
    v_max3_f32 v34, v224, v225, v226
    v_max3_f32 v33, v33, v223, v228
    v_max3_f32 v34, v34, v227, v232
    v_max3_f32 v33, v33, v229, v230
    v_max3_f32 v34, v34, v233, v234
    v_max_f32 v33, v33, v231
    v_max_f32 v34, v34, v235
    s_nop 1
    v_permlane32_swap_b32 v33, v34
    s_nop 0
    v_max_f32 v35, v33, v34
    v_max_f32 v36, v33, v34
    s_nop 1
    v_permlane16_swap_b32 v36, v35
    s_nop 0
    v_max_f32 v35, v36, v35
    v_mul_f32 v35, s55, v35
    v_max_f32 v31, v28, v35
    v_max_f32 v32, v28, v35
    v_cmp_gt_f32 vcc, v31, v28
    v_sub_f32 v37, v28, v31
    v_mov_b32 v28, v31
    v_permlane32_swap_b32 v31, v32
    s_cbranch_vccz L_norescaleD
    v_exp_f32 v38, v37
    v_exp_f32 v39, v37
    s_nop 1
    v_permlane32_swap_b32 v38, v39
    s_nop 0
    v_mul_f32 v29, v29, v38
    v_mul_f32 v30, v30, v39
    v_mul_f32 v108, v108, v38
    v_mul_f32 v109, v109, v38
    v_mul_f32 v110, v110, v38
    v_mul_f32 v111, v111, v38
    v_mul_f32 v112, v112, v38
    v_mul_f32 v113, v113, v38
    v_mul_f32 v114, v114, v38
    v_mul_f32 v115, v115, v38
    v_mul_f32 v116, v116, v38
    v_mul_f32 v117, v117, v38
    v_mul_f32 v118, v118, v38
    v_mul_f32 v119, v119, v38
    v_mul_f32 v120, v120, v38
    v_mul_f32 v121, v121, v38
    v_mul_f32 v122, v122, v38
    v_mul_f32 v123, v123, v38
    v_mul_f32 v124, v124, v38
    v_mul_f32 v125, v125, v38
    v_mul_f32 v126, v126, v38
    v_mul_f32 v127, v127, v38
    v_mul_f32 v128, v128, v38
    v_mul_f32 v129, v129, v38
    v_mul_f32 v130, v130, v38
    v_mul_f32 v131, v131, v38
    v_mul_f32 v132, v132, v38
    v_mul_f32 v133, v133, v38
    v_mul_f32 v134, v134, v38
    v_mul_f32 v135, v135, v38
    v_mul_f32 v136, v136, v38
    v_mul_f32 v137, v137, v38
    v_mul_f32 v138, v138, v38
    v_mul_f32 v139, v139, v38
    v_mul_f32 v140, v140, v39
    v_mul_f32 v141, v141, v39
    v_mul_f32 v142, v142, v39
    v_mul_f32 v143, v143, v39
    v_mul_f32 v144, v144, v39
    v_mul_f32 v145, v145, v39
    v_mul_f32 v146, v146, v39
    v_mul_f32 v147, v147, v39
    v_mul_f32 v148, v148, v39
    v_mul_f32 v149, v149, v39
    v_mul_f32 v150, v150, v39
    v_mul_f32 v151, v151, v39
    v_mul_f32 v152, v152, v39
    v_mul_f32 v153, v153, v39
    v_mul_f32 v154, v154, v39
    v_mul_f32 v155, v155, v39
    v_mul_f32 v156, v156, v39
    v_mul_f32 v157, v157, v39
    v_mul_f32 v158, v158, v39
    v_mul_f32 v159, v159, v39
    v_mul_f32 v160, v160, v39
    v_mul_f32 v161, v161, v39
    v_mul_f32 v162, v162, v39
    v_mul_f32 v163, v163, v39
    v_mul_f32 v164, v164, v39
    v_mul_f32 v165, v165, v39
    v_mul_f32 v166, v166, v39
    v_mul_f32 v167, v167, v39
    v_mul_f32 v168, v168, v39
    v_mul_f32 v169, v169, v39
    v_mul_f32 v170, v170, v39
    v_mul_f32 v171, v171, v39
L_norescaleD:
    s_waitcnt vmcnt(12)
    buffer_load_dwordx4 v14, s[20:23], s61 offen offset:2048 nt lds
    buffer_load_dwordx4 v15, s[20:23], s61 offen offset:3072 nt lds
    v_fma_f32 v220, v220, s55, -v31
    v_fma_f32 v221, v221, s55, -v31
    v_fma_f32 v222, v222, s55, -v31
    v_fma_f32 v223, v223, s55, -v31
    v_fma_f32 v224, v224, s55, -v32
    v_fma_f32 v225, v225, s55, -v32
    v_fma_f32 v226, v226, s55, -v32
    v_fma_f32 v227, v227, s55, -v32
    v_fma_f32 v228, v228, s55, -v31
    v_fma_f32 v229, v229, s55, -v31
    v_fma_f32 v230, v230, s55, -v31
    v_fma_f32 v231, v231, s55, -v31
    v_fma_f32 v232, v232, s55, -v32
    v_fma_f32 v233, v233, s55, -v32
    v_fma_f32 v234, v234, s55, -v32
    v_fma_f32 v235, v235, s55, -v32
    v_exp_f32 v220, v220
    v_exp_f32 v221, v221
    v_exp_f32 v222, v222
    v_exp_f32 v223, v223
    v_exp_f32 v224, v224
    v_exp_f32 v225, v225
    v_exp_f32 v226, v226
    v_exp_f32 v227, v227
    v_exp_f32 v228, v228
    v_exp_f32 v229, v229
    v_exp_f32 v230, v230
    v_exp_f32 v231, v231
    v_exp_f32 v232, v232
    v_exp_f32 v233, v233
    v_exp_f32 v234, v234
    v_exp_f32 v235, v235
    s_add_u32 m0, s57, 8192
    s_waitcnt vmcnt(8)
    buffer_load_dwordx4 v12, s[24:27], s60 offen nt lds
    buffer_load_dwordx4 v13, s[24:27], s60 offen offset:1024 nt lds
    ds_read_b64_tr_b16 v[204:205], v20 offset:8192
    ds_read_b64_tr_b16 v[206:207], v20 offset:12288
    ds_read_b64_tr_b16 v[208:209], v21 offset:8192
    ds_read_b64_tr_b16 v[210:211], v21 offset:12288
    ds_read_b64_tr_b16 v[212:213], v22 offset:8192
    ds_read_b64_tr_b16 v[214:215], v22 offset:12288
    ds_read_b64_tr_b16 v[216:217], v23 offset:8192
    ds_read_b64_tr_b16 v[218:219], v23 offset:12288
    v_cvt_pk_bf16_f32 v236, v220, v221
    v_cvt_pk_bf16_f32 v237, v222, v223
    v_cvt_pk_bf16_f32 v238, v228, v229
    v_cvt_pk_bf16_f32 v239, v230, v231
    v_cvt_pk_bf16_f32 v240, v224, v225
    v_cvt_pk_bf16_f32 v241, v226, v227
    v_cvt_pk_bf16_f32 v242, v232, v233
    v_cvt_pk_bf16_f32 v243, v234, v235
    v_add_f32 v220, v220, v221
    v_add_f32 v222, v222, v223
    v_add_f32 v228, v228, v229
    v_add_f32 v230, v230, v231
    v_add_f32 v220, v220, v222
    v_add_f32 v228, v228, v230
    v_add_f32 v29, v29, v220
    v_add_f32 v29, v29, v228
    v_add_f32 v224, v224, v225
    v_add_f32 v226, v226, v227
    v_add_f32 v232, v232, v233
    v_add_f32 v234, v234, v235
    v_add_f32 v224, v224, v226
    v_add_f32 v232, v232, v234
    v_add_f32 v30, v30, v224
    v_add_f32 v30, v30, v232
    s_waitcnt lgkmcnt(6)
    v_mfma_f32_16x16x32_bf16 v[108:111], v[204:207], v[236:239], v[108:111]
    v_mfma_f32_16x16x32_bf16 v[140:143], v[204:207], v[240:243], v[140:143]
    s_waitcnt lgkmcnt(4)
    v_mfma_f32_16x16x32_bf16 v[112:115], v[208:211], v[236:239], v[112:115]
    v_mfma_f32_16x16x32_bf16 v[144:147], v[208:211], v[240:243], v[144:147]
    ds_read_b64_tr_b16 v[204:205], v24 offset:8192
    ds_read_b64_tr_b16 v[206:207], v24 offset:12288
    ds_read_b64_tr_b16 v[208:209], v25 offset:8192
    ds_read_b64_tr_b16 v[210:211], v25 offset:12288
    s_waitcnt vmcnt(12)
    buffer_load_dwordx4 v14, s[24:27], s60 offen offset:2048 nt lds
    buffer_load_dwordx4 v15, s[24:27], s60 offen offset:3072 nt lds
    s_waitcnt lgkmcnt(6)
    v_mfma_f32_16x16x32_bf16 v[116:119], v[212:215], v[236:239], v[116:119]
    v_mfma_f32_16x16x32_bf16 v[148:151], v[212:215], v[240:243], v[148:151]
    s_waitcnt lgkmcnt(4)
    v_mfma_f32_16x16x32_bf16 v[120:123], v[216:219], v[236:239], v[120:123]
    v_mfma_f32_16x16x32_bf16 v[152:155], v[216:219], v[240:243], v[152:155]
    ds_read_b64_tr_b16 v[212:213], v26 offset:8192
    ds_read_b64_tr_b16 v[214:215], v26 offset:12288
    ds_read_b64_tr_b16 v[216:217], v27 offset:8192
    ds_read_b64_tr_b16 v[218:219], v27 offset:12288
    s_add_u32 m0, s57, 12288
    s_waitcnt vmcnt(12)
    buffer_load_dwordx4 v12, s[24:27], s61 offen nt lds
    buffer_load_dwordx4 v13, s[24:27], s61 offen offset:1024 nt lds
    s_waitcnt lgkmcnt(6)
    v_mfma_f32_16x16x32_bf16 v[124:127], v[204:207], v[236:239], v[124:127]
    v_mfma_f32_16x16x32_bf16 v[156:159], v[204:207], v[240:243], v[156:159]
    s_waitcnt lgkmcnt(4)
    v_mfma_f32_16x16x32_bf16 v[128:131], v[208:211], v[236:239], v[128:131]
    v_mfma_f32_16x16x32_bf16 v[160:163], v[208:211], v[240:243], v[160:163]
    s_waitcnt vmcnt(12)
    buffer_load_dwordx4 v14, s[24:27], s61 offen offset:2048 nt lds
    buffer_load_dwordx4 v15, s[24:27], s61 offen offset:3072 nt lds
    s_waitcnt lgkmcnt(2)
    v_mfma_f32_16x16x32_bf16 v[132:135], v[212:215], v[236:239], v[132:135]
    v_mfma_f32_16x16x32_bf16 v[164:167], v[212:215], v[240:243], v[164:167]
    s_waitcnt lgkmcnt(0)
    v_mfma_f32_16x16x32_bf16 v[136:139], v[216:219], v[236:239], v[136:139]
    v_mfma_f32_16x16x32_bf16 v[168:171], v[216:219], v[240:243], v[168:171]
    v_xor_b32 v16, 0x4000, v16
    v_xor_b32 v17, 0x4000, v17
    v_xor_b32 v18, 0x4000, v18
    v_xor_b32 v19, 0x4000, v19
    v_xor_b32 v20, 0x4000, v20
    v_xor_b32 v21, 0x4000, v21
    v_xor_b32 v22, 0x4000, v22
    v_xor_b32 v23, 0x4000, v23
    v_xor_b32 v24, 0x4000, v24
    v_xor_b32 v25, 0x4000, v25
    v_xor_b32 v26, 0x4000, v26
    v_xor_b32 v27, 0x4000, v27
    s_xor_b32 s57, s57, 0x4000
    s_sub_u32 s59, s59, 1
    s_cmp_lg_u32 s59, 0
.p2align 6
L_loopF2:
    v_readlane_b32 s60, v8, s58
    v_readlane_b32 s61, v9, s58
    s_sub_u32 s63, s58, 1
    v_readlane_b32 s62, v10, s63
    s_add_u32 s58, s58, 1
    s_waitcnt vmcnt(8)
    ds_read_b128 v[172:175], v16
    ds_read_b128 v[176:179], v17
    ds_read_b128 v[180:183], v18
    ds_read_b128 v[184:187], v19
    ds_read_b128 v[188:191], v16 offset:4096
    ds_read_b128 v[192:195], v17 offset:4096
    ds_read_b128 v[196:199], v18 offset:4096
    ds_read_b128 v[200:203], v19 offset:4096
    s_mov_b32 m0, s57
    s_nop 0
    buffer_load_dwordx4 v12, s[20:23], s60 offen nt lds
    buffer_load_dwordx4 v13, s[20:23], s60 offen offset:1024 nt lds
    buffer_load_dwordx4 v14, s[20:23], s60 offen offset:2048 nt lds
    buffer_load_dwordx4 v15, s[20:23], s60 offen offset:3072 nt lds
    s_add_u32 m0, s57, 4096
    s_nop 0
    buffer_load_dwordx4 v12, s[20:23], s61 offen nt lds
    buffer_load_dwordx4 v13, s[20:23], s61 offen offset:1024 nt lds
    buffer_load_dwordx4 v14, s[20:23], s61 offen offset:2048 nt lds
    buffer_load_dwordx4 v15, s[20:23], s61 offen offset:3072 nt lds
    s_add_u32 m0, s57, 8192
    s_nop 0
    buffer_load_dwordx4 v12, s[24:27], s60 offen nt lds
    buffer_load_dwordx4 v13, s[24:27], s60 offen offset:1024 nt lds
    buffer_load_dwordx4 v14, s[24:27], s60 offen offset:2048 nt lds
    buffer_load_dwordx4 v15, s[24:27], s60 offen offset:3072 nt lds
    s_add_u32 m0, s57, 12288
    s_nop 0
    buffer_load_dwordx4 v12, s[24:27], s61 offen nt lds
    buffer_load_dwordx4 v13, s[24:27], s61 offen offset:1024 nt lds
    buffer_load_dwordx4 v14, s[24:27], s61 offen offset:2048 nt lds
    buffer_load_dwordx4 v15, s[24:27], s61 offen offset:3072 nt lds
    s_waitcnt lgkmcnt(7)
    v_mfma_f32_16x16x32_bf16 v[220:223], v[172:175], v[44:47], 0
    v_mfma_f32_16x16x32_bf16 v[224:227], v[172:175], v[60:63], 0
    s_waitcnt lgkmcnt(6)
    v_mfma_f32_16x16x32_bf16 v[220:223], v[176:179], v[48:51], v[220:223]
    v_mfma_f32_16x16x32_bf16 v[224:227], v[176:179], v[64:67], v[224:227]
    s_waitcnt lgkmcnt(5)
    v_mfma_f32_16x16x32_bf16 v[220:223], v[180:183], v[52:55], v[220:223]
    v_mfma_f32_16x16x32_bf16 v[224:227], v[180:183], v[68:71], v[224:227]
    s_waitcnt lgkmcnt(4)
    v_mfma_f32_16x16x32_bf16 v[220:223], v[184:187], v[56:59], v[220:223]
    v_mfma_f32_16x16x32_bf16 v[224:227], v[184:187], v[72:75], v[224:227]
    s_waitcnt lgkmcnt(3)
    v_mfma_f32_16x16x32_bf16 v[228:231], v[188:191], v[44:47], 0
    v_mfma_f32_16x16x32_bf16 v[232:235], v[188:191], v[60:63], 0
    s_waitcnt lgkmcnt(2)
    v_mfma_f32_16x16x32_bf16 v[228:231], v[192:195], v[48:51], v[228:231]
    v_mfma_f32_16x16x32_bf16 v[232:235], v[192:195], v[64:67], v[232:235]
    s_waitcnt lgkmcnt(1)
    v_mfma_f32_16x16x32_bf16 v[228:231], v[196:199], v[52:55], v[228:231]
    v_mfma_f32_16x16x32_bf16 v[232:235], v[196:199], v[68:71], v[232:235]
    s_waitcnt lgkmcnt(0)
    v_mfma_f32_16x16x32_bf16 v[228:231], v[200:203], v[56:59], v[228:231]
    v_mfma_f32_16x16x32_bf16 v[232:235], v[200:203], v[72:75], v[232:235]
    s_nop 3
    s_nop 3
    s_cmp_eq_u32 s62, 0x1010
    s_cbranch_scc0 L_maskF2
L_nomaskF2:
    v_max3_f32 v33, v220, v221, v222
    v_max3_f32 v34, v224, v225, v226
    v_max3_f32 v33, v33, v223, v228
    v_max3_f32 v34, v34, v227, v232
    v_max3_f32 v33, v33, v229, v230
    v_max3_f32 v34, v34, v233, v234
    v_max_f32 v33, v33, v231
    v_max_f32 v34, v34, v235
    s_nop 1
    v_permlane32_swap_b32 v33, v34
    s_nop 0
    v_max_f32 v35, v33, v34
    v_max_f32 v36, v33, v34
    s_nop 1
    v_permlane16_swap_b32 v36, v35
    s_nop 0
    v_max_f32 v35, v36, v35
    v_mul_f32 v35, s55, v35
    v_max_f32 v31, v28, v35
    v_max_f32 v32, v28, v35
    v_cmp_gt_f32 vcc, v31, v28
    v_sub_f32 v37, v28, v31
    v_mov_b32 v28, v31
    v_permlane32_swap_b32 v31, v32
    s_cbranch_vccz L_norescaleF2
    v_exp_f32 v38, v37
    v_exp_f32 v39, v37
    s_nop 1
    v_permlane32_swap_b32 v38, v39
    s_nop 0
    v_mul_f32 v29, v29, v38
    v_mul_f32 v30, v30, v39
    v_mul_f32 v108, v108, v38
    v_mul_f32 v109, v109, v38
    v_mul_f32 v110, v110, v38
    v_mul_f32 v111, v111, v38
    v_mul_f32 v112, v112, v38
    v_mul_f32 v113, v113, v38
    v_mul_f32 v114, v114, v38
    v_mul_f32 v115, v115, v38
    v_mul_f32 v116, v116, v38
    v_mul_f32 v117, v117, v38
    v_mul_f32 v118, v118, v38
    v_mul_f32 v119, v119, v38
    v_mul_f32 v120, v120, v38
    v_mul_f32 v121, v121, v38
    v_mul_f32 v122, v122, v38
    v_mul_f32 v123, v123, v38
    v_mul_f32 v124, v124, v38
    v_mul_f32 v125, v125, v38
    v_mul_f32 v126, v126, v38
    v_mul_f32 v127, v127, v38
    v_mul_f32 v128, v128, v38
    v_mul_f32 v129, v129, v38
    v_mul_f32 v130, v130, v38
    v_mul_f32 v131, v131, v38
    v_mul_f32 v132, v132, v38
    v_mul_f32 v133, v133, v38
    v_mul_f32 v134, v134, v38
    v_mul_f32 v135, v135, v38
    v_mul_f32 v136, v136, v38
    v_mul_f32 v137, v137, v38
    v_mul_f32 v138, v138, v38
    v_mul_f32 v139, v139, v38
    v_mul_f32 v140, v140, v39
    v_mul_f32 v141, v141, v39
    v_mul_f32 v142, v142, v39
    v_mul_f32 v143, v143, v39
    v_mul_f32 v144, v144, v39
    v_mul_f32 v145, v145, v39
    v_mul_f32 v146, v146, v39
    v_mul_f32 v147, v147, v39
    v_mul_f32 v148, v148, v39
    v_mul_f32 v149, v149, v39
    v_mul_f32 v150, v150, v39
    v_mul_f32 v151, v151, v39
    v_mul_f32 v152, v152, v39
    v_mul_f32 v153, v153, v39
    v_mul_f32 v154, v154, v39
    v_mul_f32 v155, v155, v39
    v_mul_f32 v156, v156, v39
    v_mul_f32 v157, v157, v39
    v_mul_f32 v158, v158, v39
    v_mul_f32 v159, v159, v39
    v_mul_f32 v160, v160, v39
    v_mul_f32 v161, v161, v39
    v_mul_f32 v162, v162, v39
    v_mul_f32 v163, v163, v39
    v_mul_f32 v164, v164, v39
    v_mul_f32 v165, v165, v39
    v_mul_f32 v166, v166, v39
    v_mul_f32 v167, v167, v39
    v_mul_f32 v168, v168, v39
    v_mul_f32 v169, v169, v39
    v_mul_f32 v170, v170, v39
    v_mul_f32 v171, v171, v39
L_norescaleF2:
    v_fma_f32 v220, v220, s55, -v31
    v_fma_f32 v221, v221, s55, -v31
    v_fma_f32 v222, v222, s55, -v31
    v_fma_f32 v223, v223, s55, -v31
    v_fma_f32 v224, v224, s55, -v32
    v_fma_f32 v225, v225, s55, -v32
    v_fma_f32 v226, v226, s55, -v32
    v_fma_f32 v227, v227, s55, -v32
    v_fma_f32 v228, v228, s55, -v31
    v_fma_f32 v229, v229, s55, -v31
    v_fma_f32 v230, v230, s55, -v31
    v_fma_f32 v231, v231, s55, -v31
    v_fma_f32 v232, v232, s55, -v32
    v_fma_f32 v233, v233, s55, -v32
    v_fma_f32 v234, v234, s55, -v32
    v_fma_f32 v235, v235, s55, -v32
    v_exp_f32 v220, v220
    v_exp_f32 v221, v221
    v_exp_f32 v222, v222
    v_exp_f32 v223, v223
    v_exp_f32 v224, v224
    v_exp_f32 v225, v225
    v_exp_f32 v226, v226
    v_exp_f32 v227, v227
    v_exp_f32 v228, v228
    v_exp_f32 v229, v229
    v_exp_f32 v230, v230
    v_exp_f32 v231, v231
    v_exp_f32 v232, v232
    v_exp_f32 v233, v233
    v_exp_f32 v234, v234
    v_exp_f32 v235, v235
    s_waitcnt vmcnt(16)
    ds_read_b64_tr_b16 v[204:205], v20 offset:8192
    ds_read_b64_tr_b16 v[206:207], v20 offset:12288
    ds_read_b64_tr_b16 v[208:209], v21 offset:8192
    ds_read_b64_tr_b16 v[210:211], v21 offset:12288
    ds_read_b64_tr_b16 v[212:213], v22 offset:8192
    ds_read_b64_tr_b16 v[214:215], v22 offset:12288
    ds_read_b64_tr_b16 v[216:217], v23 offset:8192
    ds_read_b64_tr_b16 v[218:219], v23 offset:12288
    v_cvt_pk_bf16_f32 v236, v220, v221
    v_cvt_pk_bf16_f32 v237, v222, v223
    v_cvt_pk_bf16_f32 v238, v228, v229
    v_cvt_pk_bf16_f32 v239, v230, v231
    v_cvt_pk_bf16_f32 v240, v224, v225
    v_cvt_pk_bf16_f32 v241, v226, v227
    v_cvt_pk_bf16_f32 v242, v232, v233
    v_cvt_pk_bf16_f32 v243, v234, v235
    v_add_f32 v220, v220, v221
    v_add_f32 v222, v222, v223
    v_add_f32 v228, v228, v229
    v_add_f32 v230, v230, v231
    v_add_f32 v220, v220, v222
    v_add_f32 v228, v228, v230
    v_add_f32 v29, v29, v220
    v_add_f32 v29, v29, v228
    v_add_f32 v224, v224, v225
    v_add_f32 v226, v226, v227
    v_add_f32 v232, v232, v233
    v_add_f32 v234, v234, v235
    v_add_f32 v224, v224, v226
    v_add_f32 v232, v232, v234
    v_add_f32 v30, v30, v224
    v_add_f32 v30, v30, v232
    s_waitcnt lgkmcnt(6)
    v_mfma_f32_16x16x32_bf16 v[108:111], v[204:207], v[236:239], v[108:111]
    v_mfma_f32_16x16x32_bf16 v[140:143], v[204:207], v[240:243], v[140:143]
    s_waitcnt lgkmcnt(4)
    v_mfma_f32_16x16x32_bf16 v[112:115], v[208:211], v[236:239], v[112:115]
    v_mfma_f32_16x16x32_bf16 v[144:147], v[208:211], v[240:243], v[144:147]
    ds_read_b64_tr_b16 v[204:205], v24 offset:8192
    ds_read_b64_tr_b16 v[206:207], v24 offset:12288
    ds_read_b64_tr_b16 v[208:209], v25 offset:8192
    ds_read_b64_tr_b16 v[210:211], v25 offset:12288
    s_waitcnt lgkmcnt(6)
    v_mfma_f32_16x16x32_bf16 v[116:119], v[212:215], v[236:239], v[116:119]
    v_mfma_f32_16x16x32_bf16 v[148:151], v[212:215], v[240:243], v[148:151]
    s_waitcnt lgkmcnt(4)
    v_mfma_f32_16x16x32_bf16 v[120:123], v[216:219], v[236:239], v[120:123]
    v_mfma_f32_16x16x32_bf16 v[152:155], v[216:219], v[240:243], v[152:155]
    ds_read_b64_tr_b16 v[212:213], v26 offset:8192
    ds_read_b64_tr_b16 v[214:215], v26 offset:12288
    ds_read_b64_tr_b16 v[216:217], v27 offset:8192
    ds_read_b64_tr_b16 v[218:219], v27 offset:12288
    s_waitcnt lgkmcnt(6)
    v_mfma_f32_16x16x32_bf16 v[124:127], v[204:207], v[236:239], v[124:127]
    v_mfma_f32_16x16x32_bf16 v[156:159], v[204:207], v[240:243], v[156:159]
    s_waitcnt lgkmcnt(4)
    v_mfma_f32_16x16x32_bf16 v[128:131], v[208:211], v[236:239], v[128:131]
    v_mfma_f32_16x16x32_bf16 v[160:163], v[208:211], v[240:243], v[160:163]
    s_waitcnt lgkmcnt(2)
    v_mfma_f32_16x16x32_bf16 v[132:135], v[212:215], v[236:239], v[132:135]
    v_mfma_f32_16x16x32_bf16 v[164:167], v[212:215], v[240:243], v[164:167]
    s_waitcnt lgkmcnt(0)
    v_mfma_f32_16x16x32_bf16 v[136:139], v[216:219], v[236:239], v[136:139]
    v_mfma_f32_16x16x32_bf16 v[168:171], v[216:219], v[240:243], v[168:171]
    v_xor_b32 v16, 0x4000, v16
    v_xor_b32 v17, 0x4000, v17
    v_xor_b32 v18, 0x4000, v18
    v_xor_b32 v19, 0x4000, v19
    v_xor_b32 v20, 0x4000, v20
    v_xor_b32 v21, 0x4000, v21
    v_xor_b32 v22, 0x4000, v22
    v_xor_b32 v23, 0x4000, v23
    v_xor_b32 v24, 0x4000, v24
    v_xor_b32 v25, 0x4000, v25
    v_xor_b32 v26, 0x4000, v26
    v_xor_b32 v27, 0x4000, v27
    s_xor_b32 s57, s57, 0x4000
    s_sub_u32 s59, s59, 1
    s_cmp_lg_u32 s59, 0
.p2align 6
L_loopZ:
    s_sub_u32 s63, s58, 1
    v_readlane_b32 s62, v10, s63
    s_add_u32 s58, s58, 1
    s_waitcnt vmcnt(8)
    v_mov_b32 v7, s80
    s_cmp_eq_u32 s77, 0
    s_cbranch_scc1 L_z1
    buffer_load_dword v42, v7, s[44:47], 0 offen sc1
L_z1:
    ds_read_b128 v[172:175], v16
    ds_read_b128 v[176:179], v17
    ds_read_b128 v[180:183], v18
    ds_read_b128 v[184:187], v19
    ds_read_b128 v[188:191], v16 offset:4096
    ds_read_b128 v[192:195], v17 offset:4096
    ds_read_b128 v[196:199], v18 offset:4096
    ds_read_b128 v[200:203], v19 offset:4096
    s_waitcnt lgkmcnt(7)
    v_mfma_f32_16x16x32_bf16 v[220:223], v[172:175], v[44:47], 0
    v_mfma_f32_16x16x32_bf16 v[224:227], v[172:175], v[60:63], 0
    s_waitcnt lgkmcnt(6)
    v_mfma_f32_16x16x32_bf16 v[220:223], v[176:179], v[48:51], v[220:223]
    v_mfma_f32_16x16x32_bf16 v[224:227], v[176:179], v[64:67], v[224:227]
    s_waitcnt lgkmcnt(5)
    v_mfma_f32_16x16x32_bf16 v[220:223], v[180:183], v[52:55], v[220:223]
    v_mfma_f32_16x16x32_bf16 v[224:227], v[180:183], v[68:71], v[224:227]
    s_waitcnt lgkmcnt(4)
    v_mfma_f32_16x16x32_bf16 v[220:223], v[184:187], v[56:59], v[220:223]
    v_mfma_f32_16x16x32_bf16 v[224:227], v[184:187], v[72:75], v[224:227]
    s_waitcnt lgkmcnt(3)
    v_mfma_f32_16x16x32_bf16 v[228:231], v[188:191], v[44:47], 0
    v_mfma_f32_16x16x32_bf16 v[232:235], v[188:191], v[60:63], 0
    s_waitcnt lgkmcnt(2)
    v_mfma_f32_16x16x32_bf16 v[228:231], v[192:195], v[48:51], v[228:231]
    v_mfma_f32_16x16x32_bf16 v[232:235], v[192:195], v[64:67], v[232:235]
    s_waitcnt lgkmcnt(1)
    v_mfma_f32_16x16x32_bf16 v[228:231], v[196:199], v[52:55], v[228:231]
    v_mfma_f32_16x16x32_bf16 v[232:235], v[196:199], v[68:71], v[232:235]
    s_waitcnt lgkmcnt(0)
    v_mfma_f32_16x16x32_bf16 v[228:231], v[200:203], v[56:59], v[228:231]
    v_mfma_f32_16x16x32_bf16 v[232:235], v[200:203], v[72:75], v[232:235]
    s_nop 3
    s_nop 3
    s_cmp_eq_u32 s62, 0x1010
    s_cbranch_scc0 L_maskZ
L_nomaskZ:
    v_max3_f32 v33, v220, v221, v222
    v_max3_f32 v34, v224, v225, v226
    v_max3_f32 v33, v33, v223, v228
    v_max3_f32 v34, v34, v227, v232
    v_max3_f32 v33, v33, v229, v230
    v_max3_f32 v34, v34, v233, v234
    v_max_f32 v33, v33, v231
    v_max_f32 v34, v34, v235
    s_nop 1
    v_permlane32_swap_b32 v33, v34
    s_nop 0
    v_max_f32 v35, v33, v34
    v_max_f32 v36, v33, v34
    s_nop 1
    v_permlane16_swap_b32 v36, v35
    s_nop 0
    v_max_f32 v35, v36, v35
    v_mul_f32 v35, s55, v35
    v_max_f32 v31, v28, v35
    v_max_f32 v32, v28, v35
    v_cmp_gt_f32 vcc, v31, v28
    v_sub_f32 v37, v28, v31
    v_mov_b32 v28, v31
    v_permlane32_swap_b32 v31, v32
    s_cbranch_vccz L_norescaleZ
    v_exp_f32 v38, v37
    v_exp_f32 v39, v37
    s_nop 1
    v_permlane32_swap_b32 v38, v39
    s_nop 0
    v_mul_f32 v29, v29, v38
    v_mul_f32 v30, v30, v39
    v_mul_f32 v108, v108, v38
    v_mul_f32 v109, v109, v38
    v_mul_f32 v110, v110, v38
    v_mul_f32 v111, v111, v38
    v_mul_f32 v112, v112, v38
    v_mul_f32 v113, v113, v38
    v_mul_f32 v114, v114, v38
    v_mul_f32 v115, v115, v38
    v_mul_f32 v116, v116, v38
    v_mul_f32 v117, v117, v38
    v_mul_f32 v118, v118, v38
    v_mul_f32 v119, v119, v38
    v_mul_f32 v120, v120, v38
    v_mul_f32 v121, v121, v38
    v_mul_f32 v122, v122, v38
    v_mul_f32 v123, v123, v38
    v_mul_f32 v124, v124, v38
    v_mul_f32 v125, v125, v38
    v_mul_f32 v126, v126, v38
    v_mul_f32 v127, v127, v38
    v_mul_f32 v128, v128, v38
    v_mul_f32 v129, v129, v38
    v_mul_f32 v130, v130, v38
    v_mul_f32 v131, v131, v38
    v_mul_f32 v132, v132, v38
    v_mul_f32 v133, v133, v38
    v_mul_f32 v134, v134, v38
    v_mul_f32 v135, v135, v38
    v_mul_f32 v136, v136, v38
    v_mul_f32 v137, v137, v38
    v_mul_f32 v138, v138, v38
    v_mul_f32 v139, v139, v38
    v_mul_f32 v140, v140, v39
    v_mul_f32 v141, v141, v39
    v_mul_f32 v142, v142, v39
    v_mul_f32 v143, v143, v39
    v_mul_f32 v144, v144, v39
    v_mul_f32 v145, v145, v39
    v_mul_f32 v146, v146, v39
    v_mul_f32 v147, v147, v39
    v_mul_f32 v148, v148, v39
    v_mul_f32 v149, v149, v39
    v_mul_f32 v150, v150, v39
    v_mul_f32 v151, v151, v39
    v_mul_f32 v152, v152, v39
    v_mul_f32 v153, v153, v39
    v_mul_f32 v154, v154, v39
    v_mul_f32 v155, v155, v39
    v_mul_f32 v156, v156, v39
    v_mul_f32 v157, v157, v39
    v_mul_f32 v158, v158, v39
    v_mul_f32 v159, v159, v39
    v_mul_f32 v160, v160, v39
    v_mul_f32 v161, v161, v39
    v_mul_f32 v162, v162, v39
    v_mul_f32 v163, v163, v39
    v_mul_f32 v164, v164, v39
    v_mul_f32 v165, v165, v39
    v_mul_f32 v166, v166, v39
    v_mul_f32 v167, v167, v39
    v_mul_f32 v168, v168, v39
    v_mul_f32 v169, v169, v39
    v_mul_f32 v170, v170, v39
    v_mul_f32 v171, v171, v39
L_norescaleZ:
    v_fma_f32 v220, v220, s55, -v31
    v_fma_f32 v221, v221, s55, -v31
    v_fma_f32 v222, v222, s55, -v31
    v_fma_f32 v223, v223, s55, -v31
    v_fma_f32 v224, v224, s55, -v32
    v_fma_f32 v225, v225, s55, -v32
    v_fma_f32 v226, v226, s55, -v32
    v_fma_f32 v227, v227, s55, -v32
    v_fma_f32 v228, v228, s55, -v31
    v_fma_f32 v229, v229, s55, -v31
    v_fma_f32 v230, v230, s55, -v31
    v_fma_f32 v231, v231, s55, -v31
    v_fma_f32 v232, v232, s55, -v32
    v_fma_f32 v233, v233, s55, -v32
    v_fma_f32 v234, v234, s55, -v32
    v_fma_f32 v235, v235, s55, -v32
    v_exp_f32 v220, v220
    v_exp_f32 v221, v221
    v_exp_f32 v222, v222
    v_exp_f32 v223, v223
    v_exp_f32 v224, v224
    v_exp_f32 v225, v225
    v_exp_f32 v226, v226
    v_exp_f32 v227, v227
    v_exp_f32 v228, v228
    v_exp_f32 v229, v229
    v_exp_f32 v230, v230
    v_exp_f32 v231, v231
    v_exp_f32 v232, v232
    v_exp_f32 v233, v233
    v_exp_f32 v234, v234
    v_exp_f32 v235, v235
    s_waitcnt vmcnt(0)
    ds_read_b64_tr_b16 v[44:45], v20 offset:8192
    ds_read_b64_tr_b16 v[46:47], v20 offset:12288
    ds_read_b64_tr_b16 v[48:49], v21 offset:8192
    ds_read_b64_tr_b16 v[50:51], v21 offset:12288
    ds_read_b64_tr_b16 v[52:53], v22 offset:8192
    ds_read_b64_tr_b16 v[54:55], v22 offset:12288
    ds_read_b64_tr_b16 v[56:57], v23 offset:8192
    ds_read_b64_tr_b16 v[58:59], v23 offset:12288
    ds_read_b64_tr_b16 v[60:61], v24 offset:8192
    ds_read_b64_tr_b16 v[62:63], v24 offset:12288
    ds_read_b64_tr_b16 v[64:65], v25 offset:8192
    ds_read_b64_tr_b16 v[66:67], v25 offset:12288
    ds_read_b64_tr_b16 v[68:69], v26 offset:8192
    ds_read_b64_tr_b16 v[70:71], v26 offset:12288
    ds_read_b64_tr_b16 v[72:73], v27 offset:8192
    ds_read_b64_tr_b16 v[74:75], v27 offset:12288
    v_cvt_pk_bf16_f32 v236, v220, v221
    v_cvt_pk_bf16_f32 v237, v222, v223
    v_cvt_pk_bf16_f32 v238, v228, v229
    v_cvt_pk_bf16_f32 v239, v230, v231
    v_cvt_pk_bf16_f32 v240, v224, v225
    v_cvt_pk_bf16_f32 v241, v226, v227
    v_cvt_pk_bf16_f32 v242, v232, v233
    v_cvt_pk_bf16_f32 v243, v234, v235
    v_add_f32 v220, v220, v221
    v_add_f32 v222, v222, v223
    v_add_f32 v228, v228, v229
    v_add_f32 v230, v230, v231
    v_add_f32 v220, v220, v222
    v_add_f32 v228, v228, v230
    v_add_f32 v29, v29, v220
    v_add_f32 v29, v29, v228
    v_add_f32 v224, v224, v225
    v_add_f32 v226, v226, v227
    v_add_f32 v232, v232, v233
    v_add_f32 v234, v234, v235
    v_add_f32 v224, v224, v226
    v_add_f32 v232, v232, v234
    v_add_f32 v30, v30, v224
    v_add_f32 v30, v30, v232
    s_nop 1
    v_permlane32_swap_b32 v29, v30
    s_nop 0
    v_add_f32 v35, v29, v30
    v_add_f32 v36, v29, v30
    s_nop 1
    v_permlane16_swap_b32 v36, v35
    s_nop 0
    v_add_f32 v5, v36, v35
    v_mov_b32 v4, v28
    s_lshl_b32 s63, s54, 9
    s_add_u32 s63, s63, 131072
    v_lshlrev_b32 v3, 3, v0
    v_add_u32 v1, s63, v3
    ds_write_b64 v1, v[4:5]
    v_lshlrev_b32 v2, 4, v0
    s_lshl_b32 s63, s54, 12
    s_add_u32 s65, s79, s63
    s_lshl_b32 s63, s54, 9
    s_add_u32 s66, s79, s63
    s_add_u32 s66, s66, 16384
    v_mov_b32 v180, 0xff800000
    v_mov_b32 v181, 0
    s_cmp_eq_u32 s77, 0
    s_cbranch_scc1 L_nopartZ
    s_mov_b32 s82, 20000
L_pollZ:
    s_waitcnt vmcnt(0)
    v_readfirstlane_b32 s63, v42
    s_nop 3
    s_lshr_b32 s63, s63, s81
    s_and_b32 s63, s63, 0xff
    s_cmp_eq_u32 s63, 4
    s_cbranch_scc1 L_readyZ
    s_sub_u32 s82, s82, 1
    s_cbranch_scc1 L_readyZ
    s_sleep 8
    buffer_load_dword v42, v7, s[44:47], 0 offen sc1
    s_branch L_pollZ
L_readyZ:
    buffer_load_dwordx2 v[180:181], v3, s[40:43], s66 offen sc1
    buffer_load_dwordx4 v[76:79], v2, s[40:43], s65 offen offset:0 sc1
    buffer_load_dwordx4 v[80:83], v2, s[40:43], s65 offen offset:1024 sc1
    buffer_load_dwordx4 v[84:87], v2, s[40:43], s65 offen offset:2048 sc1
    buffer_load_dwordx4 v[88:91], v2, s[40:43], s65 offen offset:3072 sc1
L_nopartZ:
    v_add_u32 v1, s57, v2
    s_waitcnt lgkmcnt(1)
    v_mfma_f32_16x16x32_bf16 v[108:111], v[44:47], v[236:239], v[108:111]
    v_mfma_f32_16x16x32_bf16 v[140:143], v[44:47], v[240:243], v[140:143]
    v_mfma_f32_16x16x32_bf16 v[112:115], v[48:51], v[236:239], v[112:115]
    v_mfma_f32_16x16x32_bf16 v[144:147], v[48:51], v[240:243], v[144:147]
    v_mfma_f32_16x16x32_bf16 v[116:119], v[52:55], v[236:239], v[116:119]
    v_mfma_f32_16x16x32_bf16 v[148:151], v[52:55], v[240:243], v[148:151]
    v_mfma_f32_16x16x32_bf16 v[120:123], v[56:59], v[236:239], v[120:123]
    v_mfma_f32_16x16x32_bf16 v[152:155], v[56:59], v[240:243], v[152:155]
    s_nop 0
    ds_write_b128 v1, v[108:111] offset:0
    ds_write_b128 v1, v[140:143] offset:8192
    v_mfma_f32_16x16x32_bf16 v[124:127], v[60:63], v[236:239], v[124:127]
    v_mfma_f32_16x16x32_bf16 v[156:159], v[60:63], v[240:243], v[156:159]
    ds_write_b128 v1, v[112:115] offset:1024
    ds_write_b128 v1, v[144:147] offset:9216
    v_mfma_f32_16x16x32_bf16 v[128:131], v[64:67], v[236:239], v[128:131]
    v_mfma_f32_16x16x32_bf16 v[160:163], v[64:67], v[240:243], v[160:163]
    ds_write_b128 v1, v[116:119] offset:2048
    ds_write_b128 v1, v[148:151] offset:10240
    v_mfma_f32_16x16x32_bf16 v[132:135], v[68:71], v[236:239], v[132:135]
    v_mfma_f32_16x16x32_bf16 v[164:167], v[68:71], v[240:243], v[164:167]
    ds_write_b128 v1, v[120:123] offset:3072
    ds_write_b128 v1, v[152:155] offset:11264
    v_mfma_f32_16x16x32_bf16 v[136:139], v[72:75], v[236:239], v[136:139]
    v_mfma_f32_16x16x32_bf16 v[168:171], v[72:75], v[240:243], v[168:171]
    ds_write_b128 v1, v[124:127] offset:4096
    ds_write_b128 v1, v[156:159] offset:12288
    ds_write_b128 v1, v[128:131] offset:5120
    ds_write_b128 v1, v[160:163] offset:13312
    s_nop 1
    ds_write_b128 v1, v[132:135] offset:6144
    ds_write_b128 v1, v[164:167] offset:14336
    s_nop 1
    ds_write_b128 v1, v[136:139] offset:7168
    ds_write_b128 v1, v[168:171] offset:15360
    s_branch L_m3
L_exit:
    s_cmp_gt_u32 s76, 1
    s_cbranch_scc1 L_switch
L_merge:
    v_mov_b32 v7, s80
    s_cmp_eq_u32 s77, 0
    s_cbranch_scc1 L_m2
    buffer_load_dword v42, v7, s[44:47], 0 offen sc1
L_m2:
    v_permlane32_swap_b32 v29, v30
    s_nop 0
    v_add_f32 v35, v29, v30
    v_add_f32 v36, v29, v30
    s_nop 1
    v_permlane16_swap_b32 v36, v35
    s_nop 0
    v_add_f32 v5, v36, v35
    v_mov_b32 v4, v28
    s_lshl_b32 s63, s54, 9
    s_add_u32 s63, s63, 131072
    v_lshlrev_b32 v3, 3, v0
    v_add_u32 v1, s63, v3
    ds_write_b64 v1, v[4:5]
    v_lshlrev_b32 v2, 4, v0
    v_add_u32 v1, s57, v2
    ds_write_b128 v1, v[108:111] offset:0
    ds_write_b128 v1, v[112:115] offset:1024
    ds_write_b128 v1, v[116:119] offset:2048
    ds_write_b128 v1, v[120:123] offset:3072
    ds_write_b128 v1, v[124:127] offset:4096
    ds_write_b128 v1, v[128:131] offset:5120
    ds_write_b128 v1, v[132:135] offset:6144
    ds_write_b128 v1, v[136:139] offset:7168
    ds_write_b128 v1, v[140:143] offset:8192
    ds_write_b128 v1, v[144:147] offset:9216
    ds_write_b128 v1, v[148:151] offset:10240
    ds_write_b128 v1, v[152:155] offset:11264
    ds_write_b128 v1, v[156:159] offset:12288
    ds_write_b128 v1, v[160:163] offset:13312
    ds_write_b128 v1, v[164:167] offset:14336
    ds_write_b128 v1, v[168:171] offset:15360
    s_lshl_b32 s63, s54, 12
    s_add_u32 s65, s79, s63
    s_lshl_b32 s63, s54, 9
    s_add_u32 s66, s79, s63
    s_add_u32 s66, s66, 16384
    v_mov_b32 v180, 0xff800000
    v_mov_b32 v181, 0
    s_cmp_eq_u32 s77, 0
    s_cbranch_scc1 L_nopart
    s_mov_b32 s82, 20000
L_poll:
    s_waitcnt vmcnt(0)
    v_readfirstlane_b32 s63, v42
    s_nop 3
    s_lshr_b32 s63, s63, s81
    s_and_b32 s63, s63, 0xff
    s_cmp_eq_u32 s63, 4
    s_cbranch_scc1 L_ready
    s_sub_u32 s82, s82, 1
    s_cbranch_scc1 L_ready
    s_sleep 8
    buffer_load_dword v42, v7, s[44:47], 0 offen sc1
    s_branch L_poll
L_ready:
    buffer_load_dwordx2 v[180:181], v3, s[40:43], s66 offen sc1
    buffer_load_dwordx4 v[76:79], v2, s[40:43], s65 offen offset:0 sc1
    buffer_load_dwordx4 v[80:83], v2, s[40:43], s65 offen offset:1024 sc1
    buffer_load_dwordx4 v[84:87], v2, s[40:43], s65 offen offset:2048 sc1
    buffer_load_dwordx4 v[88:91], v2, s[40:43], s65 offen offset:3072 sc1
L_nopart:
L_m3:
    s_lshr_b32 s63, s54, 1
    s_lshl_b32 s63, s63, 8
    s_add_u32 s63, s63, 131072
    v_and_b32 v1, 0x78, v3
    v_add_u32 v1, s63, v1
    s_and_b32 s63, s57, 0x4000
    s_lshl_b32 s64, s54, 12
    s_add_u32 s63, s63, s64
    v_add_u32 v5, s63, v2
    v_add_u32 v6, 0x10000, v5
    s_waitcnt lgkmcnt(0)
    s_barrier
    ds_read_b64 v[172:173], v1 offset:0
    ds_read_b64 v[174:175], v1 offset:512
    ds_read_b64 v[176:177], v1 offset:1024
    ds_read_b64 v[178:179], v1 offset:1536
    ds_read_b128 v[108:111], v5 offset:0
    ds_read_b128 v[112:115], v5 offset:1024
    ds_read_b128 v[116:119], v5 offset:2048
    ds_read_b128 v[120:123], v5 offset:3072
    ds_read_b128 v[124:127], v5 offset:32768
    ds_read_b128 v[128:131], v5 offset:33792
    ds_read_b128 v[132:135], v5 offset:34816
    ds_read_b128 v[136:139], v5 offset:35840
    ds_read_b128 v[140:143], v6 offset:0
    ds_read_b128 v[144:147], v6 offset:1024
    ds_read_b128 v[148:151], v6 offset:2048
    ds_read_b128 v[152:155], v6 offset:3072
    ds_read_b128 v[156:159], v6 offset:32768
    ds_read_b128 v[160:163], v6 offset:33792
    ds_read_b128 v[164:167], v6 offset:34816
    ds_read_b128 v[168:171], v6 offset:35840
    s_lshl_b32 s63, s52, 5
    s_lshl_b32 s64, s53, 1
    s_add_u32 s63, s63, s64
    s_lshr_b32 s64, s54, 1
    s_add_u32 s63, s63, s64
    s_lshl_b32 s63, s63, 12
    s_and_b32 s64, s54, 1
    s_lshl_b32 s64, s64, 7
    s_add_u32 s63, s63, s64
    v_lshlrev_b32 v1, 5, v3
    v_and_b32 v1, 0xf00, v1
    v_lshl_add_u32 v1, v11, 1, v1
    s_cmp_eq_u32 s77, 0
    s_cbranch_scc1 L_m4
    s_waitcnt vmcnt(4)
L_m4:
    s_waitcnt lgkmcnt(15)
    v_max3_f32 v4, v172, v174, v176
    v_max3_f32 v4, v4, v178, v180
    v_sub_f32 v184, v172, v4
    v_sub_f32 v185, v174, v4
    v_sub_f32 v186, v176, v4
    v_sub_f32 v187, v178, v4
    v_sub_f32 v188, v180, v4
    v_exp_f32 v184, v184
    v_exp_f32 v185, v185
    v_exp_f32 v186, v186
    v_exp_f32 v187, v187
    v_exp_f32 v188, v188
    s_nop 0
    v_mul_f32 v5, v184, v173
    v_fmac_f32 v5, v185, v175
    v_fmac_f32 v5, v186, v177
    v_fmac_f32 v5, v187, v179
    v_fmac_f32 v5, v188, v181
    s_cmp_lg_u32 s76, 0
    s_cbranch_scc1 L_m5
    v_rcp_f32 v6, v5
    s_nop 0
    v_mul_f32 v184, v184, v6
    v_mul_f32 v185, v185, v6
    v_mul_f32 v186, v186, v6
    v_mul_f32 v187, v187, v6
    v_mul_f32 v188, v188, v6
L_m5:
    s_waitcnt lgkmcnt(8)
    v_pk_mul_f32 v[108:109], v[108:109], v[184:185] op_sel:[0,0] op_sel_hi:[1,0]
    v_pk_mul_f32 v[110:111], v[110:111], v[184:185] op_sel:[0,0] op_sel_hi:[1,0]
    v_pk_mul_f32 v[112:113], v[112:113], v[184:185] op_sel:[0,0] op_sel_hi:[1,0]
    v_pk_mul_f32 v[114:115], v[114:115], v[184:185] op_sel:[0,0] op_sel_hi:[1,0]
    v_pk_mul_f32 v[116:117], v[116:117], v[184:185] op_sel:[0,0] op_sel_hi:[1,0]
    v_pk_mul_f32 v[118:119], v[118:119], v[184:185] op_sel:[0,0] op_sel_hi:[1,0]
    v_pk_mul_f32 v[120:121], v[120:121], v[184:185] op_sel:[0,0] op_sel_hi:[1,0]
    v_pk_mul_f32 v[122:123], v[122:123], v[184:185] op_sel:[0,0] op_sel_hi:[1,0]
    v_pk_fma_f32 v[108:109], v[124:125], v[184:185], v[108:109] op_sel:[0,1,0] op_sel_hi:[1,1,1]
    v_pk_fma_f32 v[110:111], v[126:127], v[184:185], v[110:111] op_sel:[0,1,0] op_sel_hi:[1,1,1]
    v_pk_fma_f32 v[112:113], v[128:129], v[184:185], v[112:113] op_sel:[0,1,0] op_sel_hi:[1,1,1]
    v_pk_fma_f32 v[114:115], v[130:131], v[184:185], v[114:115] op_sel:[0,1,0] op_sel_hi:[1,1,1]
    v_pk_fma_f32 v[116:117], v[132:133], v[184:185], v[116:117] op_sel:[0,1,0] op_sel_hi:[1,1,1]
    v_pk_fma_f32 v[118:119], v[134:135], v[184:185], v[118:119] op_sel:[0,1,0] op_sel_hi:[1,1,1]
    v_pk_fma_f32 v[120:121], v[136:137], v[184:185], v[120:121] op_sel:[0,1,0] op_sel_hi:[1,1,1]
    v_pk_fma_f32 v[122:123], v[138:139], v[184:185], v[122:123] op_sel:[0,1,0] op_sel_hi:[1,1,1]
    s_waitcnt lgkmcnt(0)
    v_pk_fma_f32 v[108:109], v[140:141], v[186:187], v[108:109] op_sel:[0,0,0] op_sel_hi:[1,0,1]
    v_pk_fma_f32 v[110:111], v[142:143], v[186:187], v[110:111] op_sel:[0,0,0] op_sel_hi:[1,0,1]
    v_pk_fma_f32 v[112:113], v[144:145], v[186:187], v[112:113] op_sel:[0,0,0] op_sel_hi:[1,0,1]
    v_pk_fma_f32 v[114:115], v[146:147], v[186:187], v[114:115] op_sel:[0,0,0] op_sel_hi:[1,0,1]
    v_pk_fma_f32 v[116:117], v[148:149], v[186:187], v[116:117] op_sel:[0,0,0] op_sel_hi:[1,0,1]
    v_pk_fma_f32 v[118:119], v[150:151], v[186:187], v[118:119] op_sel:[0,0,0] op_sel_hi:[1,0,1]
    v_pk_fma_f32 v[120:121], v[152:153], v[186:187], v[120:121] op_sel:[0,0,0] op_sel_hi:[1,0,1]
    v_pk_fma_f32 v[122:123], v[154:155], v[186:187], v[122:123] op_sel:[0,0,0] op_sel_hi:[1,0,1]
    v_pk_fma_f32 v[108:109], v[156:157], v[186:187], v[108:109] op_sel:[0,1,0] op_sel_hi:[1,1,1]
    v_pk_fma_f32 v[110:111], v[158:159], v[186:187], v[110:111] op_sel:[0,1,0] op_sel_hi:[1,1,1]
    v_pk_fma_f32 v[112:113], v[160:161], v[186:187], v[112:113] op_sel:[0,1,0] op_sel_hi:[1,1,1]
    v_pk_fma_f32 v[114:115], v[162:163], v[186:187], v[114:115] op_sel:[0,1,0] op_sel_hi:[1,1,1]
    v_pk_fma_f32 v[116:117], v[164:165], v[186:187], v[116:117] op_sel:[0,1,0] op_sel_hi:[1,1,1]
    v_pk_fma_f32 v[118:119], v[166:167], v[186:187], v[118:119] op_sel:[0,1,0] op_sel_hi:[1,1,1]
    v_pk_fma_f32 v[120:121], v[168:169], v[186:187], v[120:121] op_sel:[0,1,0] op_sel_hi:[1,1,1]
    v_pk_fma_f32 v[122:123], v[170:171], v[186:187], v[122:123] op_sel:[0,1,0] op_sel_hi:[1,1,1]
    s_cmp_lg_u32 s76, 0
    s_cbranch_scc1 L_pub
    s_cmp_eq_u32 s77, 0
    s_cbranch_scc1 L_m6
    s_waitcnt vmcnt(0)
    v_pk_fma_f32 v[108:109], v[76:77], v[188:189], v[108:109] op_sel:[0,0,0] op_sel_hi:[1,0,1]
    v_pk_fma_f32 v[110:111], v[78:79], v[188:189], v[110:111] op_sel:[0,0,0] op_sel_hi:[1,0,1]
    v_pk_fma_f32 v[112:113], v[80:81], v[188:189], v[112:113] op_sel:[0,0,0] op_sel_hi:[1,0,1]
    v_pk_fma_f32 v[114:115], v[82:83], v[188:189], v[114:115] op_sel:[0,0,0] op_sel_hi:[1,0,1]
    v_pk_fma_f32 v[116:117], v[84:85], v[188:189], v[116:117] op_sel:[0,0,0] op_sel_hi:[1,0,1]
    v_pk_fma_f32 v[118:119], v[86:87], v[188:189], v[118:119] op_sel:[0,0,0] op_sel_hi:[1,0,1]
    v_pk_fma_f32 v[120:121], v[88:89], v[188:189], v[120:121] op_sel:[0,0,0] op_sel_hi:[1,0,1]
    v_pk_fma_f32 v[122:123], v[90:91], v[188:189], v[122:123] op_sel:[0,0,0] op_sel_hi:[1,0,1]
L_m6:
    v_cvt_pk_bf16_f32 v220, v108, v109
    v_cvt_pk_bf16_f32 v221, v110, v111
    buffer_store_dwordx2 v[220:221], v1, s[32:35], s63 offen offset:0
    v_cvt_pk_bf16_f32 v222, v112, v113
    v_cvt_pk_bf16_f32 v223, v114, v115
    buffer_store_dwordx2 v[222:223], v1, s[32:35], s63 offen offset:32
    v_cvt_pk_bf16_f32 v224, v116, v117
    v_cvt_pk_bf16_f32 v225, v118, v119
    buffer_store_dwordx2 v[224:225], v1, s[32:35], s63 offen offset:64
    v_cvt_pk_bf16_f32 v226, v120, v121
    v_cvt_pk_bf16_f32 v227, v122, v123
    buffer_store_dwordx2 v[226:227], v1, s[32:35], s63 offen offset:96
L_done:
    s_endpgm
L_pub:
    buffer_store_dwordx2 v[4:5], v3, s[40:43], s66 offen sc1
    buffer_store_dwordx4 v[108:111], v2, s[40:43], s65 offen offset:0 sc1
    buffer_store_dwordx4 v[112:115], v2, s[40:43], s65 offen offset:1024 sc1
    buffer_store_dwordx4 v[116:119], v2, s[40:43], s65 offen offset:2048 sc1
    buffer_store_dwordx4 v[120:123], v2, s[40:43], s65 offen offset:3072 sc1
    s_barrier
    v_swap_b32 v44, v76
    v_swap_b32 v45, v77
    v_swap_b32 v46, v78
    v_swap_b32 v47, v79
    v_swap_b32 v48, v80
    v_swap_b32 v49, v81
    v_swap_b32 v50, v82
    v_swap_b32 v51, v83
    v_swap_b32 v52, v84
    v_swap_b32 v53, v85
    v_swap_b32 v54, v86
    v_swap_b32 v55, v87
    v_swap_b32 v56, v88
    v_swap_b32 v57, v89
    v_swap_b32 v58, v90
    v_swap_b32 v59, v91
    v_swap_b32 v60, v92
    v_swap_b32 v61, v93
    v_swap_b32 v62, v94
    v_swap_b32 v63, v95
    v_swap_b32 v64, v96
    v_swap_b32 v65, v97
    v_swap_b32 v66, v98
    v_swap_b32 v67, v99
    v_swap_b32 v68, v100
    v_swap_b32 v69, v101
    v_swap_b32 v70, v102
    v_swap_b32 v71, v103
    v_swap_b32 v72, v104
    v_swap_b32 v73, v105
    v_swap_b32 v74, v106
    v_swap_b32 v75, v107
    v_accvgpr_read_b32 v108, a0
    v_accvgpr_read_b32 v109, a1
    v_accvgpr_read_b32 v110, a2
    v_accvgpr_read_b32 v111, a3
    v_accvgpr_read_b32 v112, a4
    v_accvgpr_read_b32 v113, a5
    v_accvgpr_read_b32 v114, a6
    v_accvgpr_read_b32 v115, a7
    v_accvgpr_read_b32 v116, a8
    v_accvgpr_read_b32 v117, a9
    v_accvgpr_read_b32 v118, a10
    v_accvgpr_read_b32 v119, a11
    v_accvgpr_read_b32 v120, a12
    v_accvgpr_read_b32 v121, a13
    v_accvgpr_read_b32 v122, a14
    v_accvgpr_read_b32 v123, a15
    v_accvgpr_read_b32 v124, a16
    v_accvgpr_read_b32 v125, a17
    v_accvgpr_read_b32 v126, a18
    v_accvgpr_read_b32 v127, a19
    v_accvgpr_read_b32 v128, a20
    v_accvgpr_read_b32 v129, a21
    v_accvgpr_read_b32 v130, a22
    v_accvgpr_read_b32 v131, a23
    v_accvgpr_read_b32 v132, a24
    v_accvgpr_read_b32 v133, a25
    v_accvgpr_read_b32 v134, a26
    v_accvgpr_read_b32 v135, a27
    v_accvgpr_read_b32 v136, a28
    v_accvgpr_read_b32 v137, a29
    v_accvgpr_read_b32 v138, a30
    v_accvgpr_read_b32 v139, a31
    v_accvgpr_read_b32 v140, a32
    v_accvgpr_read_b32 v141, a33
    v_accvgpr_read_b32 v142, a34
    v_accvgpr_read_b32 v143, a35
    v_accvgpr_read_b32 v144, a36
    v_accvgpr_read_b32 v145, a37
    v_accvgpr_read_b32 v146, a38
    v_accvgpr_read_b32 v147, a39
    v_accvgpr_read_b32 v148, a40
    v_accvgpr_read_b32 v149, a41
    v_accvgpr_read_b32 v150, a42
    v_accvgpr_read_b32 v151, a43
    v_accvgpr_read_b32 v152, a44
    v_accvgpr_read_b32 v153, a45
    v_accvgpr_read_b32 v154, a46
    v_accvgpr_read_b32 v155, a47
    v_accvgpr_read_b32 v156, a48
    v_accvgpr_read_b32 v157, a49
    v_accvgpr_read_b32 v158, a50
    v_accvgpr_read_b32 v159, a51
    v_accvgpr_read_b32 v160, a52
    v_accvgpr_read_b32 v161, a53
    v_accvgpr_read_b32 v162, a54
    v_accvgpr_read_b32 v163, a55
    v_accvgpr_read_b32 v164, a56
    v_accvgpr_read_b32 v165, a57
    v_accvgpr_read_b32 v166, a58
    v_accvgpr_read_b32 v167, a59
    v_accvgpr_read_b32 v168, a60
    v_accvgpr_read_b32 v169, a61
    v_accvgpr_read_b32 v170, a62
    v_accvgpr_read_b32 v171, a63
    v_accvgpr_read_b32 v28, a64
    v_accvgpr_read_b32 v29, a65
    v_accvgpr_read_b32 v30, a66
    s_mov_b32 s76, 3
    s_mov_b32 s59, 1
    s_cmp_gt_u32 s75, 1
    s_cbranch_scc1 L_loop
    s_add_u32 s75, s75, 1
L_switch:
    s_cmp_eq_u32 s76, 2
    s_cbranch_scc1 L_stash
    s_cmp_eq_u32 s76, 4
    s_cbranch_scc0 L_sig
    s_mov_b32 s76, 0
    s_cmp_eq_u32 s73, 3
    s_cbranch_scc1 L_loopD
    s_branch L_loopF2
L_sig:
    s_lshl_b32 s63, 1, s81
    v_mov_b32 v6, s63
    v_mov_b32 v7, s80
    s_cmp_eq_u32 s59, 1
    s_cbranch_scc0 L_sw
    s_waitcnt vmcnt(0)
L_sw:
    s_waitcnt vmcnt(8)
    s_mov_b64 exec, 1
    buffer_atomic_add v6, v7, s[44:47], 0 offen sc1
    s_mov_b64 exec, -1
    s_mov_b32 s76, 0
    s_sub_u32 s59, s75, 2
    s_cmp_lg_u32 s59, 0
    s_cbranch_scc1 L_loop
    s_branch L_merge
L_stash:
    v_swap_b32 v44, v76
    v_swap_b32 v45, v77
    v_swap_b32 v46, v78
    v_swap_b32 v47, v79
    v_swap_b32 v48, v80
    v_swap_b32 v49, v81
    v_swap_b32 v50, v82
    v_swap_b32 v51, v83
    v_swap_b32 v52, v84
    v_swap_b32 v53, v85
    v_swap_b32 v54, v86
    v_swap_b32 v55, v87
    v_swap_b32 v56, v88
    v_swap_b32 v57, v89
    v_swap_b32 v58, v90
    v_swap_b32 v59, v91
    v_swap_b32 v60, v92
    v_swap_b32 v61, v93
    v_swap_b32 v62, v94
    v_swap_b32 v63, v95
    v_swap_b32 v64, v96
    v_swap_b32 v65, v97
    v_swap_b32 v66, v98
    v_swap_b32 v67, v99
    v_swap_b32 v68, v100
    v_swap_b32 v69, v101
    v_swap_b32 v70, v102
    v_swap_b32 v71, v103
    v_swap_b32 v72, v104
    v_swap_b32 v73, v105
    v_swap_b32 v74, v106
    v_swap_b32 v75, v107
    v_accvgpr_write_b32 a0, v108
    v_accvgpr_write_b32 a1, v109
    v_accvgpr_write_b32 a2, v110
    v_accvgpr_write_b32 a3, v111
    v_accvgpr_write_b32 a4, v112
    v_accvgpr_write_b32 a5, v113
    v_accvgpr_write_b32 a6, v114
    v_accvgpr_write_b32 a7, v115
    v_accvgpr_write_b32 a8, v116
    v_accvgpr_write_b32 a9, v117
    v_accvgpr_write_b32 a10, v118
    v_accvgpr_write_b32 a11, v119
    v_accvgpr_write_b32 a12, v120
    v_accvgpr_write_b32 a13, v121
    v_accvgpr_write_b32 a14, v122
    v_accvgpr_write_b32 a15, v123
    v_accvgpr_write_b32 a16, v124
    v_accvgpr_write_b32 a17, v125
    v_accvgpr_write_b32 a18, v126
    v_accvgpr_write_b32 a19, v127
    v_accvgpr_write_b32 a20, v128
    v_accvgpr_write_b32 a21, v129
    v_accvgpr_write_b32 a22, v130
    v_accvgpr_write_b32 a23, v131
    v_accvgpr_write_b32 a24, v132
    v_accvgpr_write_b32 a25, v133
    v_accvgpr_write_b32 a26, v134
    v_accvgpr_write_b32 a27, v135
    v_accvgpr_write_b32 a28, v136
    v_accvgpr_write_b32 a29, v137
    v_accvgpr_write_b32 a30, v138
    v_accvgpr_write_b32 a31, v139
    v_accvgpr_write_b32 a32, v140
    v_accvgpr_write_b32 a33, v141
    v_accvgpr_write_b32 a34, v142
    v_accvgpr_write_b32 a35, v143
    v_accvgpr_write_b32 a36, v144
    v_accvgpr_write_b32 a37, v145
    v_accvgpr_write_b32 a38, v146
    v_accvgpr_write_b32 a39, v147
    v_accvgpr_write_b32 a40, v148
    v_accvgpr_write_b32 a41, v149
    v_accvgpr_write_b32 a42, v150
    v_accvgpr_write_b32 a43, v151
    v_accvgpr_write_b32 a44, v152
    v_accvgpr_write_b32 a45, v153
    v_accvgpr_write_b32 a46, v154
    v_accvgpr_write_b32 a47, v155
    v_accvgpr_write_b32 a48, v156
    v_accvgpr_write_b32 a49, v157
    v_accvgpr_write_b32 a50, v158
    v_accvgpr_write_b32 a51, v159
    v_accvgpr_write_b32 a52, v160
    v_accvgpr_write_b32 a53, v161
    v_accvgpr_write_b32 a54, v162
    v_accvgpr_write_b32 a55, v163
    v_accvgpr_write_b32 a56, v164
    v_accvgpr_write_b32 a57, v165
    v_accvgpr_write_b32 a58, v166
    v_accvgpr_write_b32 a59, v167
    v_accvgpr_write_b32 a60, v168
    v_accvgpr_write_b32 a61, v169
    v_accvgpr_write_b32 a62, v170
    v_accvgpr_write_b32 a63, v171
    v_accvgpr_write_b32 a64, v28
    v_accvgpr_write_b32 a65, v29
    v_accvgpr_write_b32 a66, v30
    v_mov_b32 v108, 0
    v_mov_b32 v109, 0
    v_mov_b32 v110, 0
    v_mov_b32 v111, 0
    v_mov_b32 v112, 0
    v_mov_b32 v113, 0
    v_mov_b32 v114, 0
    v_mov_b32 v115, 0
    v_mov_b32 v116, 0
    v_mov_b32 v117, 0
    v_mov_b32 v118, 0
    v_mov_b32 v119, 0
    v_mov_b32 v120, 0
    v_mov_b32 v121, 0
    v_mov_b32 v122, 0
    v_mov_b32 v123, 0
    v_mov_b32 v124, 0
    v_mov_b32 v125, 0
    v_mov_b32 v126, 0
    v_mov_b32 v127, 0
    v_mov_b32 v128, 0
    v_mov_b32 v129, 0
    v_mov_b32 v130, 0
    v_mov_b32 v131, 0
    v_mov_b32 v132, 0
    v_mov_b32 v133, 0
    v_mov_b32 v134, 0
    v_mov_b32 v135, 0
    v_mov_b32 v136, 0
    v_mov_b32 v137, 0
    v_mov_b32 v138, 0
    v_mov_b32 v139, 0
    v_mov_b32 v140, 0
    v_mov_b32 v141, 0
    v_mov_b32 v142, 0
    v_mov_b32 v143, 0
    v_mov_b32 v144, 0
    v_mov_b32 v145, 0
    v_mov_b32 v146, 0
    v_mov_b32 v147, 0
    v_mov_b32 v148, 0
    v_mov_b32 v149, 0
    v_mov_b32 v150, 0
    v_mov_b32 v151, 0
    v_mov_b32 v152, 0
    v_mov_b32 v153, 0
    v_mov_b32 v154, 0
    v_mov_b32 v155, 0
    v_mov_b32 v156, 0
    v_mov_b32 v157, 0
    v_mov_b32 v158, 0
    v_mov_b32 v159, 0
    v_mov_b32 v160, 0
    v_mov_b32 v161, 0
    v_mov_b32 v162, 0
    v_mov_b32 v163, 0
    v_mov_b32 v164, 0
    v_mov_b32 v165, 0
    v_mov_b32 v166, 0
    v_mov_b32 v167, 0
    v_mov_b32 v168, 0
    v_mov_b32 v169, 0
    v_mov_b32 v170, 0
    v_mov_b32 v171, 0
    v_mov_b32 v28, 0xff800000
    v_mov_b32 v29, 0
    v_mov_b32 v30, 0
    s_mov_b32 s76, 1
    s_mov_b32 s59, s74
    s_branch L_loop
L_maskF:
    v_mov_b32 v1, 0xf149f2ca
    s_and_b32 s63, s62, 0xff
    s_sub_i32 s64, s63, 0
    v_cmp_gt_i32 vcc, s64, v11
    s_nop 1
    v_cndmask_b32 v220, v1, v220, vcc
    v_cndmask_b32 v224, v1, v224, vcc
    s_sub_i32 s64, s63, 1
    v_cmp_gt_i32 vcc, s64, v11
    s_nop 1
    v_cndmask_b32 v221, v1, v221, vcc
    v_cndmask_b32 v225, v1, v225, vcc
    s_sub_i32 s64, s63, 2
    v_cmp_gt_i32 vcc, s64, v11
    s_nop 1
    v_cndmask_b32 v222, v1, v222, vcc
    v_cndmask_b32 v226, v1, v226, vcc
    s_sub_i32 s64, s63, 3
    v_cmp_gt_i32 vcc, s64, v11
    s_nop 1
    v_cndmask_b32 v223, v1, v223, vcc
    v_cndmask_b32 v227, v1, v227, vcc
    s_lshr_b32 s63, s62, 8
    s_sub_i32 s64, s63, 0
    v_cmp_gt_i32 vcc, s64, v11
    s_nop 1
    v_cndmask_b32 v228, v1, v228, vcc
    v_cndmask_b32 v232, v1, v232, vcc
    s_sub_i32 s64, s63, 1
    v_cmp_gt_i32 vcc, s64, v11
    s_nop 1
    v_cndmask_b32 v229, v1, v229, vcc
    v_cndmask_b32 v233, v1, v233, vcc
    s_sub_i32 s64, s63, 2
    v_cmp_gt_i32 vcc, s64, v11
    s_nop 1
    v_cndmask_b32 v230, v1, v230, vcc
    v_cndmask_b32 v234, v1, v234, vcc
    s_sub_i32 s64, s63, 3
    v_cmp_gt_i32 vcc, s64, v11
    s_nop 1
    v_cndmask_b32 v231, v1, v231, vcc
    v_cndmask_b32 v235, v1, v235, vcc
    s_branch L_nomaskF
L_maskA:
    v_mov_b32 v1, 0xf149f2ca
    s_and_b32 s63, s62, 0xff
    s_sub_i32 s64, s63, 0
    v_cmp_gt_i32 vcc, s64, v11
    s_nop 1
    v_cndmask_b32 v220, v1, v220, vcc
    v_cndmask_b32 v224, v1, v224, vcc
    s_sub_i32 s64, s63, 1
    v_cmp_gt_i32 vcc, s64, v11
    s_nop 1
    v_cndmask_b32 v221, v1, v221, vcc
    v_cndmask_b32 v225, v1, v225, vcc
    s_sub_i32 s64, s63, 2
    v_cmp_gt_i32 vcc, s64, v11
    s_nop 1
    v_cndmask_b32 v222, v1, v222, vcc
    v_cndmask_b32 v226, v1, v226, vcc
    s_sub_i32 s64, s63, 3
    v_cmp_gt_i32 vcc, s64, v11
    s_nop 1
    v_cndmask_b32 v223, v1, v223, vcc
    v_cndmask_b32 v227, v1, v227, vcc
    s_lshr_b32 s63, s62, 8
    s_sub_i32 s64, s63, 0
    v_cmp_gt_i32 vcc, s64, v11
    s_nop 1
    v_cndmask_b32 v228, v1, v228, vcc
    v_cndmask_b32 v232, v1, v232, vcc
    s_sub_i32 s64, s63, 1
    v_cmp_gt_i32 vcc, s64, v11
    s_nop 1
    v_cndmask_b32 v229, v1, v229, vcc
    v_cndmask_b32 v233, v1, v233, vcc
    s_sub_i32 s64, s63, 2
    v_cmp_gt_i32 vcc, s64, v11
    s_nop 1
    v_cndmask_b32 v230, v1, v230, vcc
    v_cndmask_b32 v234, v1, v234, vcc
    s_sub_i32 s64, s63, 3
    v_cmp_gt_i32 vcc, s64, v11
    s_nop 1
    v_cndmask_b32 v231, v1, v231, vcc
    v_cndmask_b32 v235, v1, v235, vcc
    s_branch L_nomaskA
L_maskB:
    v_mov_b32 v1, 0xf149f2ca
    s_and_b32 s63, s62, 0xff
    s_sub_i32 s64, s63, 0
    v_cmp_gt_i32 vcc, s64, v11
    s_nop 1
    v_cndmask_b32 v220, v1, v220, vcc
    v_cndmask_b32 v224, v1, v224, vcc
    s_sub_i32 s64, s63, 1
    v_cmp_gt_i32 vcc, s64, v11
    s_nop 1
    v_cndmask_b32 v221, v1, v221, vcc
    v_cndmask_b32 v225, v1, v225, vcc
    s_sub_i32 s64, s63, 2
    v_cmp_gt_i32 vcc, s64, v11
    s_nop 1
    v_cndmask_b32 v222, v1, v222, vcc
    v_cndmask_b32 v226, v1, v226, vcc
    s_sub_i32 s64, s63, 3
    v_cmp_gt_i32 vcc, s64, v11
    s_nop 1
    v_cndmask_b32 v223, v1, v223, vcc
    v_cndmask_b32 v227, v1, v227, vcc
    s_lshr_b32 s63, s62, 8
    s_sub_i32 s64, s63, 0
    v_cmp_gt_i32 vcc, s64, v11
    s_nop 1
    v_cndmask_b32 v228, v1, v228, vcc
    v_cndmask_b32 v232, v1, v232, vcc
    s_sub_i32 s64, s63, 1
    v_cmp_gt_i32 vcc, s64, v11
    s_nop 1
    v_cndmask_b32 v229, v1, v229, vcc
    v_cndmask_b32 v233, v1, v233, vcc
    s_sub_i32 s64, s63, 2
    v_cmp_gt_i32 vcc, s64, v11
    s_nop 1
    v_cndmask_b32 v230, v1, v230, vcc
    v_cndmask_b32 v234, v1, v234, vcc
    s_sub_i32 s64, s63, 3
    v_cmp_gt_i32 vcc, s64, v11
    s_nop 1
    v_cndmask_b32 v231, v1, v231, vcc
    v_cndmask_b32 v235, v1, v235, vcc
    s_branch L_nomaskB
L_maskP:
    v_mov_b32 v1, 0xf149f2ca
    s_and_b32 s63, s62, 0xff
    s_sub_i32 s64, s63, 0
    v_cmp_gt_i32 vcc, s64, v11
    s_nop 1
    v_cndmask_b32 v220, v1, v220, vcc
    v_cndmask_b32 v224, v1, v224, vcc
    s_sub_i32 s64, s63, 1
    v_cmp_gt_i32 vcc, s64, v11
    s_nop 1
    v_cndmask_b32 v221, v1, v221, vcc
    v_cndmask_b32 v225, v1, v225, vcc
    s_sub_i32 s64, s63, 2
    v_cmp_gt_i32 vcc, s64, v11
    s_nop 1
    v_cndmask_b32 v222, v1, v222, vcc
    v_cndmask_b32 v226, v1, v226, vcc
    s_sub_i32 s64, s63, 3
    v_cmp_gt_i32 vcc, s64, v11
    s_nop 1
    v_cndmask_b32 v223, v1, v223, vcc
    v_cndmask_b32 v227, v1, v227, vcc
    s_lshr_b32 s63, s62, 8
    s_sub_i32 s64, s63, 0
    v_cmp_gt_i32 vcc, s64, v11
    s_nop 1
    v_cndmask_b32 v228, v1, v228, vcc
    v_cndmask_b32 v232, v1, v232, vcc
    s_sub_i32 s64, s63, 1
    v_cmp_gt_i32 vcc, s64, v11
    s_nop 1
    v_cndmask_b32 v229, v1, v229, vcc
    v_cndmask_b32 v233, v1, v233, vcc
    s_sub_i32 s64, s63, 2
    v_cmp_gt_i32 vcc, s64, v11
    s_nop 1
    v_cndmask_b32 v230, v1, v230, vcc
    v_cndmask_b32 v234, v1, v234, vcc
    s_sub_i32 s64, s63, 3
    v_cmp_gt_i32 vcc, s64, v11
    s_nop 1
    v_cndmask_b32 v231, v1, v231, vcc
    v_cndmask_b32 v235, v1, v235, vcc
    s_branch L_nomaskP
L_maskF2:
    v_mov_b32 v1, 0xf149f2ca
    s_and_b32 s63, s62, 0xff
    s_sub_i32 s64, s63, 0
    v_cmp_gt_i32 vcc, s64, v11
    s_nop 1
    v_cndmask_b32 v220, v1, v220, vcc
    v_cndmask_b32 v224, v1, v224, vcc
    s_sub_i32 s64, s63, 1
    v_cmp_gt_i32 vcc, s64, v11
    s_nop 1
    v_cndmask_b32 v221, v1, v221, vcc
    v_cndmask_b32 v225, v1, v225, vcc
    s_sub_i32 s64, s63, 2
    v_cmp_gt_i32 vcc, s64, v11
    s_nop 1
    v_cndmask_b32 v222, v1, v222, vcc
    v_cndmask_b32 v226, v1, v226, vcc
    s_sub_i32 s64, s63, 3
    v_cmp_gt_i32 vcc, s64, v11
    s_nop 1
    v_cndmask_b32 v223, v1, v223, vcc
    v_cndmask_b32 v227, v1, v227, vcc
    s_lshr_b32 s63, s62, 8
    s_sub_i32 s64, s63, 0
    v_cmp_gt_i32 vcc, s64, v11
    s_nop 1
    v_cndmask_b32 v228, v1, v228, vcc
    v_cndmask_b32 v232, v1, v232, vcc
    s_sub_i32 s64, s63, 1
    v_cmp_gt_i32 vcc, s64, v11
    s_nop 1
    v_cndmask_b32 v229, v1, v229, vcc
    v_cndmask_b32 v233, v1, v233, vcc
    s_sub_i32 s64, s63, 2
    v_cmp_gt_i32 vcc, s64, v11
    s_nop 1
    v_cndmask_b32 v230, v1, v230, vcc
    v_cndmask_b32 v234, v1, v234, vcc
    s_sub_i32 s64, s63, 3
    v_cmp_gt_i32 vcc, s64, v11
    s_nop 1
    v_cndmask_b32 v231, v1, v231, vcc
    v_cndmask_b32 v235, v1, v235, vcc
    s_branch L_nomaskF2
L_maskZ:
    v_mov_b32 v1, 0xf149f2ca
    s_and_b32 s63, s62, 0xff
    s_sub_i32 s64, s63, 0
    v_cmp_gt_i32 vcc, s64, v11
    s_nop 1
    v_cndmask_b32 v220, v1, v220, vcc
    v_cndmask_b32 v224, v1, v224, vcc
    s_sub_i32 s64, s63, 1
    v_cmp_gt_i32 vcc, s64, v11
    s_nop 1
    v_cndmask_b32 v221, v1, v221, vcc
    v_cndmask_b32 v225, v1, v225, vcc
    s_sub_i32 s64, s63, 2
    v_cmp_gt_i32 vcc, s64, v11
    s_nop 1
    v_cndmask_b32 v222, v1, v222, vcc
    v_cndmask_b32 v226, v1, v226, vcc
    s_sub_i32 s64, s63, 3
    v_cmp_gt_i32 vcc, s64, v11
    s_nop 1
    v_cndmask_b32 v223, v1, v223, vcc
    v_cndmask_b32 v227, v1, v227, vcc
    s_lshr_b32 s63, s62, 8
    s_sub_i32 s64, s63, 0
    v_cmp_gt_i32 vcc, s64, v11
    s_nop 1
    v_cndmask_b32 v228, v1, v228, vcc
    v_cndmask_b32 v232, v1, v232, vcc
    s_sub_i32 s64, s63, 1
    v_cmp_gt_i32 vcc, s64, v11
    s_nop 1
    v_cndmask_b32 v229, v1, v229, vcc
    v_cndmask_b32 v233, v1, v233, vcc
    s_sub_i32 s64, s63, 2
    v_cmp_gt_i32 vcc, s64, v11
    s_nop 1
    v_cndmask_b32 v230, v1, v230, vcc
    v_cndmask_b32 v234, v1, v234, vcc
    s_sub_i32 s64, s63, 3
    v_cmp_gt_i32 vcc, s64, v11
    s_nop 1
    v_cndmask_b32 v231, v1, v231, vcc
    v_cndmask_b32 v235, v1, v235, vcc
    s_branch L_nomaskZ
L_maskD:
    v_mov_b32 v1, 0xf149f2ca
    s_and_b32 s63, s62, 0xff
    s_sub_i32 s64, s63, 0
    v_cmp_gt_i32 vcc, s64, v11
    s_nop 1
    v_cndmask_b32 v220, v1, v220, vcc
    v_cndmask_b32 v224, v1, v224, vcc
    s_sub_i32 s64, s63, 1
    v_cmp_gt_i32 vcc, s64, v11
    s_nop 1
    v_cndmask_b32 v221, v1, v221, vcc
    v_cndmask_b32 v225, v1, v225, vcc
    s_sub_i32 s64, s63, 2
    v_cmp_gt_i32 vcc, s64, v11
    s_nop 1
    v_cndmask_b32 v222, v1, v222, vcc
    v_cndmask_b32 v226, v1, v226, vcc
    s_sub_i32 s64, s63, 3
    v_cmp_gt_i32 vcc, s64, v11
    s_nop 1
    v_cndmask_b32 v223, v1, v223, vcc
    v_cndmask_b32 v227, v1, v227, vcc
    s_lshr_b32 s63, s62, 8
    s_sub_i32 s64, s63, 0
    v_cmp_gt_i32 vcc, s64, v11
    s_nop 1
    v_cndmask_b32 v228, v1, v228, vcc
    v_cndmask_b32 v232, v1, v232, vcc
    s_sub_i32 s64, s63, 1
    v_cmp_gt_i32 vcc, s64, v11
    s_nop 1
    v_cndmask_b32 v229, v1, v229, vcc
    v_cndmask_b32 v233, v1, v233, vcc
    s_sub_i32 s64, s63, 2
    v_cmp_gt_i32 vcc, s64, v11
    s_nop 1
    v_cndmask_b32 v230, v1, v230, vcc
    v_cndmask_b32 v234, v1, v234, vcc
    s_sub_i32 s64, s63, 3
    v_cmp_gt_i32 vcc, s64, v11
    s_nop 1
    v_cndmask_b32 v231, v1, v231, vcc
    v_cndmask_b32 v235, v1, v235, vcc
    s_branch L_nomaskD
L_maskQ:
    v_mov_b32 v1, 0xf149f2ca
    s_and_b32 s63, s62, 0xff
    s_sub_i32 s64, s63, 0
    v_cmp_gt_i32 vcc, s64, v11
    s_nop 1
    v_cndmask_b32 v220, v1, v220, vcc
    v_cndmask_b32 v224, v1, v224, vcc
    s_sub_i32 s64, s63, 1
    v_cmp_gt_i32 vcc, s64, v11
    s_nop 1
    v_cndmask_b32 v221, v1, v221, vcc
    v_cndmask_b32 v225, v1, v225, vcc
    s_sub_i32 s64, s63, 2
    v_cmp_gt_i32 vcc, s64, v11
    s_nop 1
    v_cndmask_b32 v222, v1, v222, vcc
    v_cndmask_b32 v226, v1, v226, vcc
    s_sub_i32 s64, s63, 3
    v_cmp_gt_i32 vcc, s64, v11
    s_nop 1
    v_cndmask_b32 v223, v1, v223, vcc
    v_cndmask_b32 v227, v1, v227, vcc
    s_lshr_b32 s63, s62, 8
    s_sub_i32 s64, s63, 0
    v_cmp_gt_i32 vcc, s64, v11
    s_nop 1
    v_cndmask_b32 v228, v1, v228, vcc
    v_cndmask_b32 v232, v1, v232, vcc
    s_sub_i32 s64, s63, 1
    v_cmp_gt_i32 vcc, s64, v11
    s_nop 1
    v_cndmask_b32 v229, v1, v229, vcc
    v_cndmask_b32 v233, v1, v233, vcc
    s_sub_i32 s64, s63, 2
    v_cmp_gt_i32 vcc, s64, v11
    s_nop 1
    v_cndmask_b32 v230, v1, v230, vcc
    v_cndmask_b32 v234, v1, v234, vcc
    s_sub_i32 s64, s63, 3
    v_cmp_gt_i32 vcc, s64, v11
    s_nop 1
    v_cndmask_b32 v231, v1, v231, vcc
    v_cndmask_b32 v235, v1, v235, vcc
    s_branch L_nomaskQ
L_maskS:
    v_mov_b32 v1, 0xf149f2ca
    s_and_b32 s63, s62, 0xff
    s_sub_i32 s64, s63, 0
    v_cmp_gt_i32 vcc, s64, v11
    s_nop 1
    v_cndmask_b32 v220, v1, v220, vcc
    v_cndmask_b32 v224, v1, v224, vcc
    s_sub_i32 s64, s63, 1
    v_cmp_gt_i32 vcc, s64, v11
    s_nop 1
    v_cndmask_b32 v221, v1, v221, vcc
    v_cndmask_b32 v225, v1, v225, vcc
    s_sub_i32 s64, s63, 2
    v_cmp_gt_i32 vcc, s64, v11
    s_nop 1
    v_cndmask_b32 v222, v1, v222, vcc
    v_cndmask_b32 v226, v1, v226, vcc
    s_sub_i32 s64, s63, 3
    v_cmp_gt_i32 vcc, s64, v11
    s_nop 1
    v_cndmask_b32 v223, v1, v223, vcc
    v_cndmask_b32 v227, v1, v227, vcc
    s_lshr_b32 s63, s62, 8
    s_sub_i32 s64, s63, 0
    v_cmp_gt_i32 vcc, s64, v11
    s_nop 1
    v_cndmask_b32 v228, v1, v228, vcc
    v_cndmask_b32 v232, v1, v232, vcc
    s_sub_i32 s64, s63, 1
    v_cmp_gt_i32 vcc, s64, v11
    s_nop 1
    v_cndmask_b32 v229, v1, v229, vcc
    v_cndmask_b32 v233, v1, v233, vcc
    s_sub_i32 s64, s63, 2
    v_cmp_gt_i32 vcc, s64, v11
    s_nop 1
    v_cndmask_b32 v230, v1, v230, vcc
    v_cndmask_b32 v234, v1, v234, vcc
    s_sub_i32 s64, s63, 3
    v_cmp_gt_i32 vcc, s64, v11
    s_nop 1
    v_cndmask_b32 v231, v1, v231, vcc
    v_cndmask_b32 v235, v1, v235, vcc
    s_branch L_nomaskS
.section .rodata,"a"
.p2align 6
.amdhsa_kernel standalone__paged_block_table_kv_pagedattention__sampling_kernel
  .amdhsa_next_free_vgpr 311
  .amdhsa_next_free_sgpr 100
  .amdhsa_accum_offset 244
  .amdhsa_group_segment_fixed_size 0
  .amdhsa_kernarg_size 64
  .amdhsa_user_sgpr_count 2
  .amdhsa_user_sgpr_kernarg_segment_ptr 1
  .amdhsa_system_sgpr_workgroup_id_x 1
.end_amdhsa_kernel
```
